```python
import torch

def _softmax(x, axis=-1):
    return torch.softmax(x, dim=axis)
def _gelu(x):
    return torch.nn.functional.gelu(x, approximate="tanh")
def _silu(x):
    return torch.nn.functional.silu(x)
def _sigmoid(x):
    return torch.sigmoid(x)
def _layernorm(x, axis=-1, eps=1e-5):
    m = x.mean(dim=axis, keepdim=True)
    v = x.var(dim=axis, keepdim=True, unbiased=False)
    return (x - m) / torch.sqrt(v + eps)
def _scatter_add(tgt, idx, src, axis=0):
    return tgt.clone().index_add_(axis, idx, src)
def _segment_sum(src, seg, n):
    out = torch.zeros((n,) + src.shape[1:], dtype=src.dtype)
    return out.index_add_(0, seg, src)
def _pad(x, pw):
    flat = tuple(v for pair in reversed(pw) for v in pair)
    return torch.nn.functional.pad(x, flat)

kernel_name = 'concat_heads__linear_attn_block__ssm_conv_s4__prompt'

def setup_inputs():

    _w = (lambda a: (lambda t: t.to(torch.bfloat16) if t.is_floating_point() else t)(torch.as_tensor(a)))
    def _A_setup():
        B, S, D = 1, 2048, 1024
        return {
            "x": _w((lambda *s: torch.randn(*s, dtype=torch.bfloat16) * 0.05)(B, S, D)),
            "wqkv": _w((lambda *s: torch.randn(*s, dtype=torch.bfloat16) * 0.8)(D, 3 * D)),
            "wo": _w((lambda *s: torch.randn(*s, dtype=torch.bfloat16) * 0.05)(D, D)),
        }
    _A_in = _A_setup()

    def _B_setup():
        B, L, D, N = 1, 2048, 1024, 128
        A_re = -(lambda _x: torch.exp(torch.as_tensor(_x)))((lambda *s: torch.randn(*s, dtype=torch.bfloat16) * 6.4)(D, N))
        A_im = torch.pi * (lambda *s: torch.randn(*s, dtype=torch.bfloat16) * 0.05)(D, N)
        B_re = (lambda *s: torch.randn(*s, dtype=torch.bfloat16) * 0.2)(D, N)
        B_im = (lambda *s: torch.randn(*s, dtype=torch.bfloat16) * 0.2)(D, N)
        C_re = (lambda *s: torch.randn(*s, dtype=torch.bfloat16) * 0.2)(D, N)
        C_im = (lambda *s: torch.randn(*s, dtype=torch.bfloat16) * 0.2)(D, N)
        log_dt = (lambda *s: torch.randn(*s, dtype=torch.bfloat16) * 0.05)(D) * 0.5 - 4.0
        Dskip = (lambda *s: torch.randn(*s, dtype=torch.bfloat16) * 0.05)(D)
        return {
            "u": _w((lambda *s: torch.randn(*s, dtype=torch.bfloat16) * 0.05)(B, L, D)),
            "A_re": _w(A_re),
            "A_im": _w(A_im),
            "B_re": _w(B_re),
            "B_im": _w(B_im),
            "C_re": _w(C_re),
            "C_im": _w(C_im),
            "log_dt": _w(log_dt),
            "Dskip": _w(Dskip),
        }
    _B_in = _B_setup()

    return {
        "A_x": _A_in["x"],
        "A_wqkv": _A_in["wqkv"],
        "A_wo": _A_in["wo"],
        "B_u": _B_in["u"],
        "B_A_re": _B_in["A_re"],
        "B_A_im": _B_in["A_im"],
        "B_B_re": _B_in["B_re"],
        "B_B_im": _B_in["B_im"],
        "B_C_re": _B_in["C_re"],
        "B_C_im": _B_in["C_im"],
        "B_log_dt": _B_in["log_dt"],
        "B_Dskip": _B_in["Dskip"],
    }

def reference(A_x, A_wqkv, A_wo, B_u, B_A_re, B_A_im, B_B_re, B_B_im, B_C_re, B_C_im, B_log_dt, B_Dskip):
    def _A_ref(x, wqkv, wo):
        B, S, D = x.shape
        H = 32; Dh = D // H
        qkv = (lambda x, *d: x.permute(*d))((x @ wqkv).reshape(B, S, 3, H, Dh), 2, 0, 3, 1, 4)
        q, k, v = qkv[0], qkv[1], qkv[2]
        phi = lambda t: torch.where(t > 0, t + 1, torch.exp(t)) + 1e-6
        pq, pk = phi(q), phi(k)
        kv = torch.einsum("bhsd,bhse->bhde", pk, v)
        z = torch.einsum("bhsd->bhd", pk)
        num = torch.einsum("bhqd,bhde->bhqe", pq, kv)
        den = torch.einsum("bhqd,bhd->bhq", pq, z)[..., None] + 1e-6
        o = num / den
        return (lambda x, *d: x.permute(*d))(o, 0, 2, 1, 3).reshape(B, S, D) @ wo

    def _B_ref(u, A_re, A_im, B_re, B_im, C_re, C_im, log_dt, Dskip):
        Bsz, L, D = u.shape
        dt = torch.exp(log_dt)[:, None]
        A = A_re + 1j * A_im
        Bc = B_re + 1j * B_im
        Cc = C_re + 1j * C_im
        logdA = dt * A
        dB = dt * Bc
        l = (lambda x, dt: x.to(dt))(torch.arange(L), A_re.dtype)
        P = torch.exp(logdA[:, :, None] * l[None, None, :])
        K = torch.einsum("dn,dnl,dn->dl", Cc, P, dB).real
        L2 = 2 * L
        Kp = _pad(K, ((0, 0), (0, L)))
        up = (lambda x, *d: x.permute(*d))(u, 0, 2, 1)
        up = _pad(up, ((0, 0), (0, 0), (0, L)))
        Kf = (lambda x, axes=(-2,-1): torch.fft.rfft2(x.float(), dim=axes))(Kp[:, None, :], axes=(-2, -1))
        Uf = (lambda x, axes=(-2,-1): torch.fft.rfft2(x.float(), dim=axes))(up[:, :, None, :], axes=(-2, -1))
        Yf = Uf * Kf[None, :, :, :]
        y = (lambda x, s, axes=(-2,-1): torch.fft.irfft2(x, s=s, dim=axes).to(torch.bfloat16))(Yf, (1, L2), axes=(-2, -1))[:, :, 0, :L]
        y = (lambda x, *d: x.permute(*d))(y, 0, 2, 1) + u * Dskip[None, None, :]
        return y

    a = _A_ref(A_x, A_wqkv, A_wo)
    b = _B_ref(B_u, B_A_re, B_A_im, B_B_re, B_B_im, B_C_re, B_C_im, B_log_dt, B_Dskip)
    return torch.concatenate([a, b], axis=-1)
```

```asm
; @launch grid=(256,1,1) block=(512,1,1) lds=163840
.amdgcn_target "amdgcn-amd-amdhsa--gfx950"
.text
.globl concat_heads__linear_attn_block__ssm_conv_s4__prompt_kernel
.p2align 8
.type concat_heads__linear_attn_block__ssm_conv_s4__prompt_kernel,@function
concat_heads__linear_attn_block__ssm_conv_s4__prompt_kernel:
    s_cmp_ge_u32 s2, 256
    s_cbranch_scc1 L_end
    s_load_dwordx16 s[4:19], s[0:1], 0
    s_load_dwordx8 s[20:27], s[0:1], 64
    s_load_dwordx4 s[28:31], s[0:1], 96
    s_load_dwordx2 s[32:33], s[0:1], 112
    v_lshrrev_b32 v1, 6, v0
    v_and_b32 v0, 63, v0
    s_getpc_b64 s[34:35]
    v_readfirstlane_b32 s66, v1
    s_and_b32 s60, s2, 7
    s_lshr_b32 s61, s2, 3
    s_lshl_b32 s68, s60, 1
    s_lshr_b32 s69, s61, 4
    s_add_u32 s64, s68, s69
    s_add_u32 s65, s61, 1
    s_and_b32 s65, s65, 15
    s_lshl_b32 s68, s64, 6
    s_lshl_b32 s69, s65, 2
    s_add_u32 s68, s68, s69
    s_and_b32 s69, s66, 3
    s_add_u32 s101, s68, s69
    s_cmp_ge_u32 s66, 4
    s_cbranch_scc1 L_S
    s_cmp_lg_u32 s66, 0
    s_cbranch_scc1 L_nopf
    v_min_u32 v2, 6, v0
    v_lshlrev_b32_e64 v2, 5, v2
    v_add_lshl_u32 v2, v2, s61, 7
    v_min_u32 v2, 26980, v2
    global_load_dword v250, v2, s[34:35]
L_nopf:
    s_lshl_b32 s68, s101, 8
    v_lshl_add_u32 v5, v0, 2, s68
    s_lshl_b32 s68, s101, 1
    v_mov_b32 v6, s68
    s_waitcnt lgkmcnt(0)
    global_load_ushort v246, v6, s[24:25]
    global_load_dword v240, v5, s[12:13] nt
    global_load_dword v241, v5, s[14:15] nt
    global_load_dword v242, v5, s[16:17] nt
    global_load_dword v243, v5, s[18:19] nt
    global_load_dword v244, v5, s[20:21] nt
    global_load_dword v245, v5, s[22:23] nt
    global_load_ushort v247, v6, s[26:27]
    s_mul_i32 s76, s66, 8704
    s_add_u32 s76, s76, 1024
    s_mov_b32 m0, s76
    s_setprio 2
    s_mov_b32 s77, 0
    v_and_b32 v5, 31, v0
    v_lshrrev_b32 v6, 5, v0
    v_lshlrev_b32 v6, 4, v6
    v_add_u32_e64 v6, s76, v6
    v_mul_u32_u24 v2, 272, v5
    v_add_u32 v12, v2, v6
    v_mov_b32 v13, v12
    v_cmp_eq_u32_e64 vcc, 5, v5
    v_add_u32 v2, 1088, v6
    v_mov_b32 v11, 0
    v_cndmask_b32 v13, v13, v2, vcc
    v_cmp_eq_u32_e64 vcc, 12, v5
    v_add_u32 v2, 1904, v6
    v_mov_b32 v10, 0
    v_cndmask_b32 v13, v13, v2, vcc
    v_cmp_eq_u32_e64 vcc, 13, v5
    v_add_u32 v2, 1904, v6
    v_mov_b32 v9, 0
    v_cndmask_b32 v13, v13, v2, vcc
    v_cmp_eq_u32_e64 vcc, 20, v5
    v_add_u32 v2, 4080, v6
    v_mov_b32 v8, 0
    v_cndmask_b32 v13, v13, v2, vcc
    v_lshlrev_b32_e64 v15, 4, v0
    s_mov_b32 s46, 2097152
    s_mov_b32 s47, 0x20000
    s_mov_b32 s54, 16777216
    s_mov_b32 s55, 0x20000
    s_mov_b32 s58, 8388608
    s_mov_b32 s59, 0x20000
    s_mov_b64 s[44:45], s[8:9]
    s_mov_b64 s[52:53], s[32:33]
    s_mov_b64 s[56:57], s[28:29]
    v_lshlrev_b32 v2, 2, v0
    ds_write_b32 v2, v8
    s_and_b32 s68, s60, 3
    s_lshl_b32 s68, s68, 2
    s_and_b32 s69, s61, 3
    s_add_u32 s62, s68, s69
    s_lshr_b32 s68, s60, 2
    s_lshl_b32 s68, s68, 3
    s_lshr_b32 s70, s61, 2
    s_add_u32 s63, s68, s70
    s_add_u32 s67, s69, s70
    s_lshl_b32 s68, s60, 1
    s_add_u32 s69, s65, s68
    s_lshl_b32 s69, s69, 0
    s_and_b32 s100, s69, 15
    s_mov_b32 s34, s64
    s_mov_b32 s35, s65
    s_mov_b32 s70, 1069066811
    s_and_b32 s73, s66, 1
    s_lshr_b32 s74, s66, 1
    s_lshl_b32 s75, s62, 1
    s_add_u32 s75, s75, s74
    s_mul_i32 s81, s66, 4864
    s_add_u32 s81, s81, 1024
    s_add_u32 s68, s81, 1072
    v_sub_u32 v14, s68, v15
    s_add_u32 s68, s81, 4540
    v_and_b32 v2, 62, v0
    v_lshlrev_b32 v2, 1, v2
    v_sub_u32 v252, s68, v2
    v_and_b32 v2, 15, v0
    v_lshl_add_u32 v3, v2, 2, s81
    v_mov_b32 v7, v3
    v_cmp_le_u32 vcc, 16, v0
    v_add_u32 v2, 2240, v3
    s_nop 0
    v_cndmask_b32 v7, v7, v2, vcc
    v_cmp_le_u32_e64 vcc, 32, v0
    v_add_u32 v2, 4352, v3
    s_nop 0
    v_cndmask_b32 v7, v7, v2, vcc
    v_cmp_le_u32_e64 vcc, 40, v0
    v_add_u32 v2, 2080, v3
    s_nop 0
    v_cndmask_b32 v7, v7, v2, vcc
    v_cmp_le_u32_e64 vcc, 48, v0
    v_add_u32 v2, 4672, v3
    s_nop 0
    v_cndmask_b32 v7, v7, v2, vcc
    v_and_b32 v2, 46, v0
    v_cmp_eq_u32 vcc, 14, v2
    v_cmp_eq_u32 s[78:79], 13, v0
    v_mov_b32 v2, 0xffff0000
    v_cndmask_b32 v253, 0, -1, vcc
    v_cndmask_b32 v253, v253, v2, s[78:79]
    s_waitcnt vmcnt(7)
    v_lshlrev_b32 v246, 16, v246
    v_mul_f32 v100, 1069066752, v246
    v_rndne_f32 v101, v100
    v_sub_f32 v100, v100, v101
    v_fmac_f32 v100, 921478512, v246
    v_exp_f32 v100, v100
    v_cvt_i32_f32 v101, v101
    v_ldexp_f32 v100, v100, v101
    v_cvt_pk_bf16_f32 v100, v100, v100
    v_lshlrev_b32 v80, 16, v100
    s_waitcnt vmcnt(0)
    v_lshlrev_b32 v82, 16, v240
    v_lshlrev_b32 v83, 16, v241
    v_lshlrev_b32 v84, 16, v242
    v_lshlrev_b32 v85, 16, v243
    v_lshlrev_b32 v86, 16, v244
    v_lshlrev_b32 v87, 16, v245
    v_mul_f32 v82, v80, v82
    v_mul_f32 v83, v80, v83
    v_mul_f32 v84, v80, v84
    v_mul_f32 v85, v80, v85
    v_mul_f32 v82, s70, v82
    v_mul_f32 v83, 0.15915494, v83
    v_mul_f32 v94, v85, v87
    v_mul_f32 v95, v85, v86
    v_fma_f32 v153, v84, v87, v95
    v_fma_f32 v152, v84, v86, -v94
    v_mul_f32 v100, 1090519040, v82
    v_mul_f32 v101, 1090519040, v83
    v_exp_f32 v100, v100
    v_fract_f32 v101, v101
    v_cos_f32 v90, v101
    v_sin_f32 v91, v101
    v_mul_f32 v90, v90, v100
    v_mul_f32 v91, v91, v100
    v_exp_f32 v100, v82
    v_fract_f32 v101, v83
    v_cos_f32 v88, v101
    v_sin_f32 v89, v101
    v_mul_f32 v88, v88, v100
    v_mul_f32 v89, v89, v100
    v_mul_f32 v100, 1132462080, v82
    v_mul_f32 v101, 1132462080, v83
    v_exp_f32 v100, v100
    v_fract_f32 v101, v101
    v_cos_f32 v92, v101
    v_sin_f32 v93, v101
    v_mul_f32 v92, v92, v100
    v_mul_f32 v93, v93, v100
    .p2align 3
L_kl:
    v_mov_b32 v96, 0x3f80
    ds_write_addtid_b32 v96
    v_cvt_pk_bf16_f32 v97, v90, v91
    ds_write_addtid_b32 v97 offset:272
    v_pk_mul_f32 v[94:95], v[90:91], v[90:91] op_sel_hi:[0,1]
    v_pk_fma_f32 v[98:99], v[90:91], v[90:91], v[94:95] op_sel:[1,1,0] op_sel_hi:[1,0,1] neg_lo:[0,1,0]
    v_cvt_pk_bf16_f32 v96, v98, v99
    ds_write_addtid_b32 v96 offset:544
    v_pk_mul_f32 v[94:95], v[98:99], v[90:91] op_sel_hi:[0,1]
    v_pk_fma_f32 v[98:99], v[98:99], v[90:91], v[94:95] op_sel:[1,1,0] op_sel_hi:[1,0,1] neg_lo:[0,1,0]
    v_cvt_pk_bf16_f32 v97, v98, v99
    ds_write_addtid_b32 v97 offset:816
    v_pk_mul_f32 v[94:95], v[98:99], v[90:91] op_sel_hi:[0,1]
    v_pk_fma_f32 v[98:99], v[98:99], v[90:91], v[94:95] op_sel:[1,1,0] op_sel_hi:[1,0,1] neg_lo:[0,1,0]
    v_cvt_pk_bf16_f32 v96, v98, v99
    ds_write_addtid_b32 v96 offset:1088
    v_pk_mul_f32 v[94:95], v[98:99], v[90:91] op_sel_hi:[0,1]
    v_pk_fma_f32 v[98:99], v[98:99], v[90:91], v[94:95] op_sel:[1,1,0] op_sel_hi:[1,0,1] neg_lo:[0,1,0]
    v_cvt_pk_bf16_f32 v97, v98, v99
    ds_write_addtid_b32 v97 offset:1360
    v_pk_mul_f32 v[94:95], v[98:99], v[90:91] op_sel_hi:[0,1]
    v_pk_fma_f32 v[98:99], v[98:99], v[90:91], v[94:95] op_sel:[1,1,0] op_sel_hi:[1,0,1] neg_lo:[0,1,0]
    v_cvt_pk_bf16_f32 v96, v98, v99
    ds_write_addtid_b32 v96 offset:1632
    v_pk_mul_f32 v[94:95], v[98:99], v[90:91] op_sel_hi:[0,1]
    v_pk_fma_f32 v[98:99], v[98:99], v[90:91], v[94:95] op_sel:[1,1,0] op_sel_hi:[1,0,1] neg_lo:[0,1,0]
    v_cvt_pk_bf16_f32 v97, v98, v99
    ds_write_addtid_b32 v97 offset:1904
    v_pk_mul_f32 v[94:95], v[98:99], v[90:91] op_sel_hi:[0,1]
    v_pk_fma_f32 v[98:99], v[98:99], v[90:91], v[94:95] op_sel:[1,1,0] op_sel_hi:[1,0,1] neg_lo:[0,1,0]
    v_cvt_pk_bf16_f32 v96, v98, v99
    ds_write_addtid_b32 v96 offset:2176
    v_pk_mul_f32 v[94:95], v[98:99], v[90:91] op_sel_hi:[0,1]
    v_pk_fma_f32 v[98:99], v[98:99], v[90:91], v[94:95] op_sel:[1,1,0] op_sel_hi:[1,0,1] neg_lo:[0,1,0]
    v_cvt_pk_bf16_f32 v97, v98, v99
    ds_write_addtid_b32 v97 offset:2448
    v_pk_mul_f32 v[94:95], v[98:99], v[90:91] op_sel_hi:[0,1]
    v_pk_fma_f32 v[98:99], v[98:99], v[90:91], v[94:95] op_sel:[1,1,0] op_sel_hi:[1,0,1] neg_lo:[0,1,0]
    v_cvt_pk_bf16_f32 v96, v98, v99
    ds_write_addtid_b32 v96 offset:2720
    v_pk_mul_f32 v[94:95], v[98:99], v[90:91] op_sel_hi:[0,1]
    v_pk_fma_f32 v[98:99], v[98:99], v[90:91], v[94:95] op_sel:[1,1,0] op_sel_hi:[1,0,1] neg_lo:[0,1,0]
    v_cvt_pk_bf16_f32 v97, v98, v99
    ds_write_addtid_b32 v97 offset:2992
    v_pk_mul_f32 v[94:95], v[98:99], v[90:91] op_sel_hi:[0,1]
    v_pk_fma_f32 v[98:99], v[98:99], v[90:91], v[94:95] op_sel:[1,1,0] op_sel_hi:[1,0,1] neg_lo:[0,1,0]
    v_cvt_pk_bf16_f32 v96, v98, v99
    ds_write_addtid_b32 v96 offset:3264
    v_pk_mul_f32 v[94:95], v[98:99], v[90:91] op_sel_hi:[0,1]
    v_pk_fma_f32 v[98:99], v[98:99], v[90:91], v[94:95] op_sel:[1,1,0] op_sel_hi:[1,0,1] neg_lo:[0,1,0]
    v_cvt_pk_bf16_f32 v97, v98, v99
    ds_write_addtid_b32 v97 offset:3536
    v_pk_mul_f32 v[94:95], v[98:99], v[90:91] op_sel_hi:[0,1]
    v_pk_fma_f32 v[98:99], v[98:99], v[90:91], v[94:95] op_sel:[1,1,0] op_sel_hi:[1,0,1] neg_lo:[0,1,0]
    v_cvt_pk_bf16_f32 v96, v98, v99
    ds_write_addtid_b32 v96 offset:3808
    v_pk_mul_f32 v[94:95], v[98:99], v[90:91] op_sel_hi:[0,1]
    v_pk_fma_f32 v[98:99], v[98:99], v[90:91], v[94:95] op_sel:[1,1,0] op_sel_hi:[1,0,1] neg_lo:[0,1,0]
    v_cvt_pk_bf16_f32 v97, v98, v99
    ds_write_addtid_b32 v97 offset:4080
    v_pk_mul_f32 v[94:95], v[98:99], v[90:91] op_sel_hi:[0,1]
    v_pk_fma_f32 v[98:99], v[98:99], v[90:91], v[94:95] op_sel:[1,1,0] op_sel_hi:[1,0,1] neg_lo:[0,1,0]
    v_cvt_pk_bf16_f32 v96, v98, v99
    ds_write_addtid_b32 v96 offset:4352
    v_pk_mul_f32 v[94:95], v[98:99], v[90:91] op_sel_hi:[0,1]
    v_pk_fma_f32 v[98:99], v[98:99], v[90:91], v[94:95] op_sel:[1,1,0] op_sel_hi:[1,0,1] neg_lo:[0,1,0]
    v_cvt_pk_bf16_f32 v97, v98, v99
    ds_write_addtid_b32 v97 offset:4624
    v_pk_mul_f32 v[94:95], v[98:99], v[90:91] op_sel_hi:[0,1]
    v_pk_fma_f32 v[98:99], v[98:99], v[90:91], v[94:95] op_sel:[1,1,0] op_sel_hi:[1,0,1] neg_lo:[0,1,0]
    v_cvt_pk_bf16_f32 v96, v98, v99
    ds_write_addtid_b32 v96 offset:4896
    v_pk_mul_f32 v[94:95], v[98:99], v[90:91] op_sel_hi:[0,1]
    v_pk_fma_f32 v[98:99], v[98:99], v[90:91], v[94:95] op_sel:[1,1,0] op_sel_hi:[1,0,1] neg_lo:[0,1,0]
    v_cvt_pk_bf16_f32 v97, v98, v99
    ds_write_addtid_b32 v97 offset:5168
    v_pk_mul_f32 v[94:95], v[98:99], v[90:91] op_sel_hi:[0,1]
    v_pk_fma_f32 v[98:99], v[98:99], v[90:91], v[94:95] op_sel:[1,1,0] op_sel_hi:[1,0,1] neg_lo:[0,1,0]
    v_cvt_pk_bf16_f32 v96, v98, v99
    ds_write_addtid_b32 v96 offset:5440
    v_pk_mul_f32 v[94:95], v[98:99], v[90:91] op_sel_hi:[0,1]
    v_pk_fma_f32 v[98:99], v[98:99], v[90:91], v[94:95] op_sel:[1,1,0] op_sel_hi:[1,0,1] neg_lo:[0,1,0]
    v_cvt_pk_bf16_f32 v97, v98, v99
    ds_write_addtid_b32 v97 offset:5712
    v_pk_mul_f32 v[94:95], v[98:99], v[90:91] op_sel_hi:[0,1]
    v_pk_fma_f32 v[98:99], v[98:99], v[90:91], v[94:95] op_sel:[1,1,0] op_sel_hi:[1,0,1] neg_lo:[0,1,0]
    v_cvt_pk_bf16_f32 v96, v98, v99
    ds_write_addtid_b32 v96 offset:5984
    v_pk_mul_f32 v[94:95], v[98:99], v[90:91] op_sel_hi:[0,1]
    v_pk_fma_f32 v[98:99], v[98:99], v[90:91], v[94:95] op_sel:[1,1,0] op_sel_hi:[1,0,1] neg_lo:[0,1,0]
    v_cvt_pk_bf16_f32 v97, v98, v99
    ds_write_addtid_b32 v97 offset:6256
    v_pk_mul_f32 v[94:95], v[98:99], v[90:91] op_sel_hi:[0,1]
    v_pk_fma_f32 v[98:99], v[98:99], v[90:91], v[94:95] op_sel:[1,1,0] op_sel_hi:[1,0,1] neg_lo:[0,1,0]
    v_cvt_pk_bf16_f32 v96, v98, v99
    ds_write_addtid_b32 v96 offset:6528
    v_pk_mul_f32 v[94:95], v[98:99], v[90:91] op_sel_hi:[0,1]
    v_pk_fma_f32 v[98:99], v[98:99], v[90:91], v[94:95] op_sel:[1,1,0] op_sel_hi:[1,0,1] neg_lo:[0,1,0]
    v_cvt_pk_bf16_f32 v97, v98, v99
    ds_write_addtid_b32 v97 offset:6800
    v_pk_mul_f32 v[94:95], v[98:99], v[90:91] op_sel_hi:[0,1]
    v_pk_fma_f32 v[98:99], v[98:99], v[90:91], v[94:95] op_sel:[1,1,0] op_sel_hi:[1,0,1] neg_lo:[0,1,0]
    v_cvt_pk_bf16_f32 v96, v98, v99
    ds_write_addtid_b32 v96 offset:7072
    v_pk_mul_f32 v[94:95], v[98:99], v[90:91] op_sel_hi:[0,1]
    v_pk_fma_f32 v[98:99], v[98:99], v[90:91], v[94:95] op_sel:[1,1,0] op_sel_hi:[1,0,1] neg_lo:[0,1,0]
    v_cvt_pk_bf16_f32 v97, v98, v99
    ds_write_addtid_b32 v97 offset:7344
    v_pk_mul_f32 v[94:95], v[98:99], v[90:91] op_sel_hi:[0,1]
    v_pk_fma_f32 v[98:99], v[98:99], v[90:91], v[94:95] op_sel:[1,1,0] op_sel_hi:[1,0,1] neg_lo:[0,1,0]
    v_cvt_pk_bf16_f32 v96, v98, v99
    ds_write_addtid_b32 v96 offset:7616
    v_pk_mul_f32 v[94:95], v[98:99], v[90:91] op_sel_hi:[0,1]
    v_pk_fma_f32 v[98:99], v[98:99], v[90:91], v[94:95] op_sel:[1,1,0] op_sel_hi:[1,0,1] neg_lo:[0,1,0]
    v_cvt_pk_bf16_f32 v97, v98, v99
    ds_write_addtid_b32 v97 offset:7888
    v_pk_mul_f32 v[94:95], v[98:99], v[90:91] op_sel_hi:[0,1]
    v_pk_fma_f32 v[98:99], v[98:99], v[90:91], v[94:95] op_sel:[1,1,0] op_sel_hi:[1,0,1] neg_lo:[0,1,0]
    v_cvt_pk_bf16_f32 v96, v98, v99
    ds_write_addtid_b32 v96 offset:8160
    v_pk_mul_f32 v[94:95], v[98:99], v[90:91] op_sel_hi:[0,1]
    v_pk_fma_f32 v[98:99], v[98:99], v[90:91], v[94:95] op_sel:[1,1,0] op_sel_hi:[1,0,1] neg_lo:[0,1,0]
    v_cvt_pk_bf16_f32 v97, v98, v99
    ds_write_addtid_b32 v97 offset:8432
    ds_read_b128 v[16:19], v12 offset:0
    ds_read_b128 v[20:23], v12 offset:32
    ds_read_b128 v[24:27], v12 offset:64
    ds_read_b128 v[28:31], v12 offset:96
    ds_read_b128 v[32:35], v12 offset:128
    ds_read_b128 v[36:39], v12 offset:160
    ds_read_b128 v[40:43], v12 offset:192
    ds_read_b128 v[44:47], v12 offset:224
    v_cvt_pk_bf16_f32 v96, v152, -v153
    ds_write_addtid_b32 v96 offset:0
    v_pk_mul_f32 v[94:95], v[152:153], v[88:89] op_sel_hi:[0,1]
    v_pk_fma_f32 v[154:155], v[152:153], v[88:89], v[94:95] op_sel:[1,1,0] op_sel_hi:[1,0,1] neg_lo:[0,1,0]
    v_cvt_pk_bf16_f32 v97, v154, -v155
    ds_write_addtid_b32 v97 offset:272
    v_pk_mul_f32 v[94:95], v[154:155], v[88:89] op_sel_hi:[0,1]
    v_pk_fma_f32 v[156:157], v[154:155], v[88:89], v[94:95] op_sel:[1,1,0] op_sel_hi:[1,0,1] neg_lo:[0,1,0]
    v_cvt_pk_bf16_f32 v96, v156, -v157
    ds_write_addtid_b32 v96 offset:544
    v_pk_mul_f32 v[94:95], v[156:157], v[88:89] op_sel_hi:[0,1]
    v_pk_fma_f32 v[158:159], v[156:157], v[88:89], v[94:95] op_sel:[1,1,0] op_sel_hi:[1,0,1] neg_lo:[0,1,0]
    v_cvt_pk_bf16_f32 v97, v158, -v159
    ds_write_addtid_b32 v97 offset:816
    v_pk_mul_f32 v[94:95], v[158:159], v[88:89] op_sel_hi:[0,1]
    v_pk_fma_f32 v[160:161], v[158:159], v[88:89], v[94:95] op_sel:[1,1,0] op_sel_hi:[1,0,1] neg_lo:[0,1,0]
    v_cvt_pk_bf16_f32 v96, v160, -v161
    ds_write_addtid_b32 v96 offset:2176
    v_pk_mul_f32 v[94:95], v[160:161], v[88:89] op_sel_hi:[0,1]
    v_pk_fma_f32 v[162:163], v[160:161], v[88:89], v[94:95] op_sel:[1,1,0] op_sel_hi:[1,0,1] neg_lo:[0,1,0]
    v_cvt_pk_bf16_f32 v97, v162, -v163
    ds_write_addtid_b32 v97 offset:2448
    v_pk_mul_f32 v[94:95], v[162:163], v[88:89] op_sel_hi:[0,1]
    v_pk_fma_f32 v[164:165], v[162:163], v[88:89], v[94:95] op_sel:[1,1,0] op_sel_hi:[1,0,1] neg_lo:[0,1,0]
    v_cvt_pk_bf16_f32 v96, v164, -v165
    ds_write_addtid_b32 v96 offset:2720
    v_pk_mul_f32 v[94:95], v[164:165], v[88:89] op_sel_hi:[0,1]
    v_pk_fma_f32 v[166:167], v[164:165], v[88:89], v[94:95] op_sel:[1,1,0] op_sel_hi:[1,0,1] neg_lo:[0,1,0]
    v_cvt_pk_bf16_f32 v97, v166, -v167
    ds_write_addtid_b32 v97 offset:2992
    v_pk_mul_f32 v[94:95], v[166:167], v[88:89] op_sel_hi:[0,1]
    v_pk_fma_f32 v[168:169], v[166:167], v[88:89], v[94:95] op_sel:[1,1,0] op_sel_hi:[1,0,1] neg_lo:[0,1,0]
    v_cvt_pk_bf16_f32 v96, v168, -v169
    ds_write_addtid_b32 v96 offset:4352
    v_pk_mul_f32 v[94:95], v[152:153], v[92:93] op_sel_hi:[0,1]
    v_pk_fma_f32 v[152:153], v[152:153], v[92:93], v[94:95] op_sel:[1,1,0] op_sel_hi:[1,0,1] neg_lo:[0,1,0]
    v_cvt_pk_bf16_f32 v97, v152, -v153
    ds_write_addtid_b32 v97 offset:1088
    v_pk_mul_f32 v[94:95], v[156:157], v[92:93] op_sel_hi:[0,1]
    v_pk_fma_f32 v[156:157], v[156:157], v[92:93], v[94:95] op_sel:[1,1,0] op_sel_hi:[1,0,1] neg_lo:[0,1,0]
    v_cvt_pk_bf16_f32 v96, v156, -v157
    ds_write_addtid_b32 v96 offset:1632
    v_pk_mul_f32 v[94:95], v[160:161], v[92:93] op_sel_hi:[0,1]
    v_pk_fma_f32 v[160:161], v[160:161], v[92:93], v[94:95] op_sel:[1,1,0] op_sel_hi:[1,0,1] neg_lo:[0,1,0]
    v_cvt_pk_bf16_f32 v97, v160, -v161
    ds_write_addtid_b32 v97 offset:1904
    v_pk_mul_f32 v[94:95], v[164:165], v[92:93] op_sel_hi:[0,1]
    v_pk_fma_f32 v[164:165], v[164:165], v[92:93], v[94:95] op_sel:[1,1,0] op_sel_hi:[1,0,1] neg_lo:[0,1,0]
    v_cvt_pk_bf16_f32 v96, v164, -v165
    ds_write_addtid_b32 v96 offset:3808
    v_pk_mul_f32 v[94:95], v[168:169], v[92:93] op_sel_hi:[0,1]
    v_pk_fma_f32 v[168:169], v[168:169], v[92:93], v[94:95] op_sel:[1,1,0] op_sel_hi:[1,0,1] neg_lo:[0,1,0]
    v_cvt_pk_bf16_f32 v97, v168, -v169
    ds_write_addtid_b32 v97 offset:4080
    v_pk_mul_f32 v[94:95], v[152:153], v[92:93] op_sel_hi:[0,1]
    v_pk_fma_f32 v[152:153], v[152:153], v[92:93], v[94:95] op_sel:[1,1,0] op_sel_hi:[1,0,1] neg_lo:[0,1,0]
    v_cvt_pk_bf16_f32 v96, v152, -v153
    ds_write_addtid_b32 v96 offset:4624
    v_pk_mul_f32 v[94:95], v[160:161], v[92:93] op_sel_hi:[0,1]
    v_pk_fma_f32 v[160:161], v[160:161], v[92:93], v[94:95] op_sel:[1,1,0] op_sel_hi:[1,0,1] neg_lo:[0,1,0]
    v_cvt_pk_bf16_f32 v97, v160, -v161
    ds_write_addtid_b32 v97 offset:4896
    v_pk_mul_f32 v[94:95], v[168:169], v[92:93] op_sel_hi:[0,1]
    v_pk_fma_f32 v[168:169], v[168:169], v[92:93], v[94:95] op_sel:[1,1,0] op_sel_hi:[1,0,1] neg_lo:[0,1,0]
    v_cvt_pk_bf16_f32 v96, v168, -v169
    ds_write_addtid_b32 v96 offset:5168
    v_pk_mul_f32 v[94:95], v[152:153], v[92:93] op_sel_hi:[0,1]
    v_pk_fma_f32 v[152:153], v[152:153], v[92:93], v[94:95] op_sel:[1,1,0] op_sel_hi:[1,0,1] neg_lo:[0,1,0]
    v_cvt_pk_bf16_f32 v97, v152, -v153
    ds_write_addtid_b32 v97 offset:5712
    v_pk_mul_f32 v[94:95], v[160:161], v[92:93] op_sel_hi:[0,1]
    v_pk_fma_f32 v[160:161], v[160:161], v[92:93], v[94:95] op_sel:[1,1,0] op_sel_hi:[1,0,1] neg_lo:[0,1,0]
    v_cvt_pk_bf16_f32 v96, v160, -v161
    ds_write_addtid_b32 v96 offset:5984
    v_pk_mul_f32 v[94:95], v[168:169], v[92:93] op_sel_hi:[0,1]
    v_pk_fma_f32 v[168:169], v[168:169], v[92:93], v[94:95] op_sel:[1,1,0] op_sel_hi:[1,0,1] neg_lo:[0,1,0]
    v_cvt_pk_bf16_f32 v97, v168, -v169
    ds_write_addtid_b32 v97 offset:6256
    v_pk_mul_f32 v[94:95], v[168:169], v[92:93] op_sel_hi:[0,1]
    v_pk_fma_f32 v[168:169], v[168:169], v[92:93], v[94:95] op_sel:[1,1,0] op_sel_hi:[1,0,1] neg_lo:[0,1,0]
    v_cvt_pk_bf16_f32 v96, v168, -v169
    ds_write_addtid_b32 v96 offset:6528
    v_pk_mul_f32 v[94:95], v[168:169], v[92:93] op_sel_hi:[0,1]
    v_pk_fma_f32 v[168:169], v[168:169], v[92:93], v[94:95] op_sel:[1,1,0] op_sel_hi:[1,0,1] neg_lo:[0,1,0]
    v_cvt_pk_bf16_f32 v97, v168, -v169
    ds_write_addtid_b32 v97 offset:7616
    v_pk_mul_f32 v[94:95], v[168:169], v[92:93] op_sel_hi:[0,1]
    v_pk_fma_f32 v[168:169], v[168:169], v[92:93], v[94:95] op_sel:[1,1,0] op_sel_hi:[1,0,1] neg_lo:[0,1,0]
    v_cvt_pk_bf16_f32 v96, v168, -v169
    ds_write_addtid_b32 v96 offset:6800
    v_pk_mul_f32 v[94:95], v[168:169], v[92:93] op_sel_hi:[0,1]
    v_pk_fma_f32 v[168:169], v[168:169], v[92:93], v[94:95] op_sel:[1,1,0] op_sel_hi:[1,0,1] neg_lo:[0,1,0]
    v_cvt_pk_bf16_f32 v97, v168, -v169
    ds_write_addtid_b32 v97 offset:7888
    ds_read_b128 v[48:51], v13 offset:0
    ds_read_b128 v[52:55], v13 offset:32
    ds_read_b128 v[56:59], v13 offset:64
    ds_read_b128 v[60:63], v13 offset:96
    ds_read_b128 v[64:67], v13 offset:128
    ds_read_b128 v[68:71], v13 offset:160
    ds_read_b128 v[72:75], v13 offset:192
    ds_read_b128 v[76:79], v13 offset:224
    s_cmp_eq_u32 s77, 1
    s_cbranch_scc1 L_kd
    v_and_b32 v82, 0xffff0000, v240
    v_and_b32 v83, 0xffff0000, v241
    v_and_b32 v84, 0xffff0000, v242
    v_and_b32 v85, 0xffff0000, v243
    v_and_b32 v86, 0xffff0000, v244
    v_and_b32 v87, 0xffff0000, v245
    v_mul_f32 v82, v80, v82
    v_mul_f32 v83, v80, v83
    v_mul_f32 v84, v80, v84
    v_mul_f32_e64 v85, v80, v85
    s_waitcnt lgkmcnt(7)
    v_mfma_f32_32x32x16_bf16 v[208:223], v[48:51], v[16:19], 0
    v_mul_f32 v82, s70, v82
    v_mul_f32 v83, 0.15915494, v83
    v_mul_f32 v94, v85, v87
    v_mul_f32_e64 v95, v85, v86
    s_waitcnt lgkmcnt(6)
    v_mfma_f32_32x32x16_bf16 v[208:223], v[52:55], v[20:23], v[208:223]
    v_fma_f32 v153, v84, v87, v95
    v_fma_f32 v152, v84, v86, -v94
    v_mul_f32 v100, 1090519040, v82
    v_mul_f32 v101, 1090519040, v83
    s_waitcnt lgkmcnt(5)
    v_mfma_f32_32x32x16_bf16 v[208:223], v[56:59], v[24:27], v[208:223]
    v_exp_f32 v100, v100
    v_fract_f32 v101, v101
    v_cos_f32 v90, v101
    v_sin_f32 v91, v101
    s_waitcnt lgkmcnt(4)
    v_mfma_f32_32x32x16_bf16 v[208:223], v[60:63], v[28:31], v[208:223]
    v_mul_f32 v90, v90, v100
    v_mul_f32 v91, v91, v100
    v_exp_f32 v100, v82
    v_fract_f32_e64 v101, v83
    s_waitcnt lgkmcnt(3)
    v_mfma_f32_32x32x16_bf16 v[208:223], v[64:67], v[32:35], v[208:223]
    v_cos_f32 v88, v101
    v_sin_f32 v89, v101
    v_mul_f32 v88, v88, v100
    v_mul_f32_e64 v89, v89, v100
    s_waitcnt lgkmcnt(2)
    v_mfma_f32_32x32x16_bf16 v[208:223], v[68:71], v[36:39], v[208:223]
    v_mul_f32 v100, 1132462080, v82
    v_mul_f32 v101, 1132462080, v83
    v_exp_f32 v100, v100
    v_fract_f32_e64 v101, v101
    s_waitcnt lgkmcnt(1)
    v_mfma_f32_32x32x16_bf16 v[208:223], v[72:75], v[40:43], v[208:223]
    v_cos_f32 v92, v101
    v_sin_f32 v93, v101
    v_mul_f32 v92, v92, v100
    v_mul_f32_e64 v93, v93, v100
    s_waitcnt lgkmcnt(0)
    v_mfma_f32_32x32x16_bf16 v[208:223], v[76:79], v[44:47], v[208:223]
    s_mov_b32 s77, 1
    s_branch L_kl
L_kd:
    v_and_b32 v2, 15, v0
    v_lshrrev_b32 v3, 4, v0
    v_bfe_u32 v4, v0, 1, 3
    v_xor_b32 v4, v4, v3
    v_lshlrev_b32 v4, 4, v4
    v_lshl_add_u32 v4, v2, 7, v4
    s_lshl_b32 s68, s73, 13
    s_add_u32 s68, s68, 40960
    v_add_u32 v192, s68, v4
    v_xor_b32 v193, 64, v192
    s_waitcnt lgkmcnt(7)
    v_mfma_f32_32x32x16_bf16 v[208:223], v[48:51], v[16:19], v[208:223]
    v_bfe_u32 v4, v0, 2, 2
    v_lshl_add_u32 v5, v3, 3, v4
    v_lshlrev_b32 v5, 7, v5
    v_and_b32_e64 v1, 3, v0
    s_waitcnt lgkmcnt(6)
    v_mfma_f32_32x32x16_bf16 v[208:223], v[52:55], v[20:23], v[208:223]
    v_lshl_add_u32 v5, v1, 3, v5
    v_lshlrev_b32_e64 v1, 2, v1
    v_bfe_u32 v6, v0, 3, 2
    s_lshl_b32 s68, s74, 1
    s_waitcnt lgkmcnt(5)
    v_mfma_f32_32x32x16_bf16 v[208:223], v[56:59], v[24:27], v[208:223]
    v_xor_b32_e64 v6, s68, v6
    v_lshl_add_u32 v5, v6, 5, v5
    v_add_u32 v194, 57344, v5
    v_xor_b32 v195, 32, v194
    s_waitcnt lgkmcnt(4)
    v_mfma_f32_32x32x16_bf16 v[208:223], v[60:63], v[28:31], v[208:223]
    v_add_u32 v196, 40960, v192
    v_add_u32 v197, 40960, v193
    v_add_u32 v198, 40960, v194
    v_add_u32 v199, 40960, v195
    s_waitcnt lgkmcnt(3)
    v_mfma_f32_32x32x16_bf16 v[208:223], v[64:67], v[32:35], v[208:223]
    v_add_u32 v200, 81920, v192
    v_add_u32 v201, 81920, v193
    v_add_u32 v202, 81920, v194
    v_add_u32 v203, 81920, v195
    s_waitcnt lgkmcnt(2)
    v_mfma_f32_32x32x16_bf16 v[208:223], v[68:71], v[36:39], v[208:223]
    v_cmp_eq_u32 vcc, 0, v0
    v_lshlrev_b32 v247, 16, v247
    v_cmp_eq_u32 s[4:5], 32, v0
    v_cndmask_b32 v247, 0, v247, vcc
    s_waitcnt lgkmcnt(1)
    v_mfma_f32_32x32x16_bf16 v[208:223], v[72:75], v[40:43], v[208:223]
    s_mov_b32 s77, 0
    v_lshlrev_b32 v206, 2, v3
    v_sub_u32 v206, v2, v206
    v_lshlrev_b32_e64 v254, 6, v2
    s_waitcnt lgkmcnt(0)
    v_mfma_f32_32x32x16_bf16 v[208:223], v[76:79], v[44:47], v[208:223]
    v_lshl_add_u32 v254, v3, 4, v254
    s_barrier
    s_nop 0
    ds_read_b128 v[112:115], v192 offset:0
    ds_read_b64_tr_b16 v[136:137], v194 offset:8192
    ds_read_b64_tr_b16 v[138:139], v194 offset:8704
    ds_read_b128 v[116:119], v192 offset:2048
    ds_read_b128 v[120:123], v192 offset:4096
    ds_read_b128 v[124:127], v192 offset:6144
    ds_read_b64_tr_b16 v[140:141], v195 offset:8192
    ds_read_b64_tr_b16 v[142:143], v195 offset:8704
    ds_read_b64_tr_b16 v[144:145], v194 offset:16384
    ds_read_b64_tr_b16 v[146:147], v194 offset:16896
    ds_read_b64_tr_b16 v[148:149], v195 offset:16384
    ds_read_b64_tr_b16 v[150:151], v195 offset:16896
    ds_read_b64_tr_b16 v[128:129], v194 offset:0
    ds_read_b64_tr_b16 v[130:131], v194 offset:512
    ds_read_b64_tr_b16 v[132:133], v195 offset:0
    ds_read_b64_tr_b16 v[134:135], v195 offset:512
    v_add_f32_e64 v208, v208, v247
    v_cvt_pk_bf16_f32 v224, v219, v219
    v_cvt_pk_bf16_f32 v225, v218, v218
    v_cvt_pk_bf16_f32 v226, v218, v217
    v_cvt_pk_bf16_f32 v227, v217, v217
    ds_write_b128 v14, v[224:227] offset:0
    v_cvt_pk_bf16_f32 v240, v208, v10
    v_cvt_pk_bf16_f32 v228, v219, v219
    v_cvt_pk_bf16_f32 v229, v219, v218
    v_cvt_pk_bf16_f32 v230, v218, v218
    v_cvt_pk_bf16_f32 v231, v217, v217
    ds_write_b128 v14, v[228:231] offset:2240
    s_waitcnt lgkmcnt(2)
    s_nop 0
    v_mfma_f32_16x16x32_bf16 v[48:51], v[112:115], v[136:139], 1.0
    ds_read_b128 v[152:155], v193 offset:0
    v_readlane_b32 s68, v224, 63
    v_mfma_f32_16x16x32_bf16 v[56:59], v[116:119], v[136:139], 1.0
    v_readlane_b32 s69, v240, 0
    v_cvt_pk_bf16_f32 v232, v215, v214
    v_mfma_f32_16x16x32_bf16 v[64:67], v[120:123], v[136:139], 1.0
    ds_read_b64_tr_b16 v[176:177], v194 offset:12288
    v_cvt_pk_bf16_f32 v233, v213, v212
    v_mfma_f32_16x16x32_bf16 v[72:75], v[124:127], v[136:139], 1.0
    ds_read_b64_tr_b16 v[178:179], v194 offset:12800
    v_cvt_pk_bf16_f32 v234, v211, v210
    v_mfma_f32_16x16x32_bf16 v[76:79], v[124:127], v[140:143], 1.0
    ds_read_b128 v[156:159], v193 offset:2048
    v_cvt_pk_bf16_f32 v235, v209, v208
    v_mfma_f32_16x16x32_bf16 v[68:71], v[120:123], v[140:143], 1.0
    ds_read_b128 v[160:163], v193 offset:4096
    ds_write_b128 v14, v[232:235] offset:1024
    v_mfma_f32_16x16x32_bf16 v[60:63], v[116:119], v[140:143], 1.0
    ds_read_b128 v[164:167], v193 offset:6144
    v_and_b32_e64 v240, s68, v253
    v_mfma_f32_16x16x32_bf16 v[52:55], v[112:115], v[140:143], 1.0
    ds_read_b64_tr_b16 v[180:181], v195 offset:12288
    v_mov_b32_e64 v241, s69
    v_mfma_f32_16x16x32_bf16 v[80:83], v[112:115], v[144:147], 0
    ds_read_b64_tr_b16 v[182:183], v195 offset:12800
    v_cvt_pk_bf16_f32 v236, v216, v215
    v_mfma_f32_16x16x32_bf16 v[88:91], v[116:119], v[144:147], 0
    ds_read_b64_tr_b16 v[184:185], v194 offset:20480
    v_cvt_pk_bf16_f32 v237, v214, v213
    v_mfma_f32_16x16x32_bf16 v[96:99], v[120:123], v[144:147], 0
    v_cvt_pk_bf16_f32 v238, v212, v211
    v_cvt_pk_bf16_f32 v239, v210, v209
    v_mfma_f32_16x16x32_bf16 v[104:107], v[124:127], v[144:147], 0
    ds_read_b64_tr_b16 v[186:187], v194 offset:20992
    ds_write_b128 v14, v[236:239] offset:3264
    v_mfma_f32_16x16x32_bf16 v[108:111], v[124:127], v[148:151], 0
    ds_read_b64_tr_b16 v[188:189], v195 offset:20480
    v_cndmask_b32 v240, v240, v241, s[4:5]
    v_mfma_f32_16x16x32_bf16 v[100:103], v[120:123], v[148:151], 0
    ds_read_b64_tr_b16 v[190:191], v195 offset:20992
    v_mov_b32_dpp v242, v220 quad_perm:[0,0,2,2] row_mask:0xf bank_mask:0xf
    v_mfma_f32_16x16x32_bf16 v[92:95], v[116:119], v[148:151], 0
    ds_read_b64_tr_b16 v[168:169], v194 offset:4096
    v_mov_b32_dpp v243, v220 quad_perm:[1,1,3,3] row_mask:0xf bank_mask:0xf
    v_mfma_f32_16x16x32_bf16 v[84:87], v[112:115], v[148:151], 0
    ds_read_b64_tr_b16 v[170:171], v194 offset:4608
    v_mov_b32_dpp v244, v221 quad_perm:[0,0,2,2] row_mask:0xf bank_mask:0xf
    v_mfma_f32_16x16x32_bf16 v[16:19], v[128:131], v[112:115], 1.0
    ds_read_b64_tr_b16 v[172:173], v195 offset:4096
    v_mov_b32_dpp v245, v221 quad_perm:[1,1,3,3] row_mask:0xf bank_mask:0xf
    v_mfma_f32_16x16x32_bf16 v[24:27], v[128:131], v[116:119], 1.0
    ds_read_b64_tr_b16 v[174:175], v195 offset:4608
    ds_write_b32 v7, v240
    v_mfma_f32_16x16x32_bf16 v[32:35], v[128:131], v[120:123], 1.0
    v_cvt_pk_bf16_f32 v242, v242, v243
    v_cvt_pk_bf16_f32 v243, v244, v245
    v_mfma_f32_16x16x32_bf16 v[40:43], v[128:131], v[124:127], 1.0
    ds_write2_b32 v252, v242, v243 offset0:32 offset1:0
    v_mfma_f32_16x16x32_bf16 v[44:47], v[132:135], v[124:127], 1.0
    v_mfma_f32_16x16x32_bf16 v[36:39], v[132:135], v[120:123], 1.0
    v_mfma_f32_16x16x32_bf16 v[28:31], v[132:135], v[116:119], 1.0
    s_waitcnt lgkmcnt(0)
    s_barrier
    v_mfma_f32_16x16x32_bf16 v[20:23], v[132:135], v[112:115], 1.0
    s_branch L_p1a
    .p2align 3
L_p1:
    v_mfma_f32_16x16x32_bf16 v[48:51], v[112:115], v[136:139], v[48:51]
    ds_read_b128 v[152:155], v193 offset:0
    v_mfma_f32_16x16x32_bf16 v[56:59], v[116:119], v[136:139], v[56:59]
    v_mfma_f32_16x16x32_bf16 v[64:67], v[120:123], v[136:139], v[64:67]
    ds_read_b64_tr_b16 v[176:177], v194 offset:12288
    v_mfma_f32_16x16x32_bf16 v[72:75], v[124:127], v[136:139], v[72:75]
    ds_read_b64_tr_b16 v[178:179], v194 offset:12800
    v_mfma_f32_16x16x32_bf16 v[76:79], v[124:127], v[140:143], v[76:79]
    ds_read_b128 v[156:159], v193 offset:2048
    v_mfma_f32_16x16x32_bf16 v[68:71], v[120:123], v[140:143], v[68:71]
    ds_read_b128 v[160:163], v193 offset:4096
    v_mfma_f32_16x16x32_bf16 v[60:63], v[116:119], v[140:143], v[60:63]
    ds_read_b128 v[164:167], v193 offset:6144
    v_mfma_f32_16x16x32_bf16 v[52:55], v[112:115], v[140:143], v[52:55]
    ds_read_b64_tr_b16 v[180:181], v195 offset:12288
    v_mfma_f32_16x16x32_bf16 v[80:83], v[112:115], v[144:147], v[80:83]
    ds_read_b64_tr_b16 v[182:183], v195 offset:12800
    v_mfma_f32_16x16x32_bf16 v[88:91], v[116:119], v[144:147], v[88:91]
    ds_read_b64_tr_b16 v[184:185], v194 offset:20480
    v_mfma_f32_16x16x32_bf16 v[96:99], v[120:123], v[144:147], v[96:99]
    v_mfma_f32_16x16x32_bf16 v[104:107], v[124:127], v[144:147], v[104:107]
    ds_read_b64_tr_b16 v[186:187], v194 offset:20992
    v_mfma_f32_16x16x32_bf16 v[108:111], v[124:127], v[148:151], v[108:111]
    ds_read_b64_tr_b16 v[188:189], v195 offset:20480
    v_mfma_f32_16x16x32_bf16 v[100:103], v[120:123], v[148:151], v[100:103]
    ds_read_b64_tr_b16 v[190:191], v195 offset:20992
    v_mfma_f32_16x16x32_bf16 v[92:95], v[116:119], v[148:151], v[92:95]
    ds_read_b64_tr_b16 v[168:169], v194 offset:4096
    v_mfma_f32_16x16x32_bf16 v[84:87], v[112:115], v[148:151], v[84:87]
    ds_read_b64_tr_b16 v[170:171], v194 offset:4608
    v_mfma_f32_16x16x32_bf16 v[16:19], v[128:131], v[112:115], v[16:19]
    ds_read_b64_tr_b16 v[172:173], v195 offset:4096
    v_mfma_f32_16x16x32_bf16 v[24:27], v[128:131], v[116:119], v[24:27]
    ds_read_b64_tr_b16 v[174:175], v195 offset:4608
    v_mfma_f32_16x16x32_bf16 v[32:35], v[128:131], v[120:123], v[32:35]
    v_mfma_f32_16x16x32_bf16 v[40:43], v[128:131], v[124:127], v[40:43]
    v_mfma_f32_16x16x32_bf16 v[44:47], v[132:135], v[124:127], v[44:47]
    v_mfma_f32_16x16x32_bf16 v[36:39], v[132:135], v[120:123], v[36:39]
    v_mfma_f32_16x16x32_bf16 v[28:31], v[132:135], v[116:119], v[28:31]
    s_waitcnt lgkmcnt(0)
    s_barrier
    v_mfma_f32_16x16x32_bf16 v[20:23], v[132:135], v[112:115], v[20:23]
L_p1a:
    v_mfma_f32_16x16x32_bf16 v[48:51], v[152:155], v[176:179], v[48:51]
    ds_read_b128 v[112:115], v196 offset:0
    v_mfma_f32_16x16x32_bf16 v[56:59], v[156:159], v[176:179], v[56:59]
    v_mfma_f32_16x16x32_bf16 v[64:67], v[160:163], v[176:179], v[64:67]
    ds_read_b64_tr_b16 v[136:137], v198 offset:8192
    v_mfma_f32_16x16x32_bf16 v[72:75], v[164:167], v[176:179], v[72:75]
    ds_read_b64_tr_b16 v[138:139], v198 offset:8704
    v_mfma_f32_16x16x32_bf16 v[76:79], v[164:167], v[180:183], v[76:79]
    ds_read_b128 v[116:119], v196 offset:2048
    v_mfma_f32_16x16x32_bf16 v[68:71], v[160:163], v[180:183], v[68:71]
    ds_read_b128 v[120:123], v196 offset:4096
    v_mfma_f32_16x16x32_bf16 v[60:63], v[156:159], v[180:183], v[60:63]
    ds_read_b128 v[124:127], v196 offset:6144
    v_mfma_f32_16x16x32_bf16 v[52:55], v[152:155], v[180:183], v[52:55]
    ds_read_b64_tr_b16 v[140:141], v199 offset:8192
    v_mfma_f32_16x16x32_bf16 v[80:83], v[152:155], v[184:187], v[80:83]
    ds_read_b64_tr_b16 v[142:143], v199 offset:8704
    v_mfma_f32_16x16x32_bf16 v[88:91], v[156:159], v[184:187], v[88:91]
    ds_read_b64_tr_b16 v[144:145], v198 offset:16384
    v_mfma_f32_16x16x32_bf16 v[96:99], v[160:163], v[184:187], v[96:99]
    v_mfma_f32_16x16x32_bf16 v[104:107], v[164:167], v[184:187], v[104:107]
    ds_read_b64_tr_b16 v[146:147], v198 offset:16896
    v_mfma_f32_16x16x32_bf16 v[108:111], v[164:167], v[188:191], v[108:111]
    ds_read_b64_tr_b16 v[148:149], v199 offset:16384
    v_mfma_f32_16x16x32_bf16 v[100:103], v[160:163], v[188:191], v[100:103]
    ds_read_b64_tr_b16 v[150:151], v199 offset:16896
    v_mfma_f32_16x16x32_bf16 v[92:95], v[156:159], v[188:191], v[92:95]
    ds_read_b64_tr_b16 v[128:129], v198 offset:0
    v_mfma_f32_16x16x32_bf16 v[84:87], v[152:155], v[188:191], v[84:87]
    ds_read_b64_tr_b16 v[130:131], v198 offset:512
    v_mfma_f32_16x16x32_bf16 v[16:19], v[168:171], v[152:155], v[16:19]
    ds_read_b64_tr_b16 v[132:133], v199 offset:0
    v_mfma_f32_16x16x32_bf16 v[24:27], v[168:171], v[156:159], v[24:27]
    ds_read_b64_tr_b16 v[134:135], v199 offset:512
    v_mfma_f32_16x16x32_bf16 v[32:35], v[168:171], v[160:163], v[32:35]
    v_mfma_f32_16x16x32_bf16 v[40:43], v[168:171], v[164:167], v[40:43]
    v_mfma_f32_16x16x32_bf16 v[44:47], v[172:175], v[164:167], v[44:47]
    v_mfma_f32_16x16x32_bf16 v[36:39], v[172:175], v[160:163], v[36:39]
    v_mfma_f32_16x16x32_bf16 v[28:31], v[172:175], v[156:159], v[28:31]
    v_mfma_f32_16x16x32_bf16 v[20:23], v[172:175], v[152:155], v[20:23]
    s_waitcnt lgkmcnt(0)
    s_nop 0
    v_mfma_f32_16x16x32_bf16 v[48:51], v[112:115], v[136:139], v[48:51]
    ds_read_b128 v[152:155], v197 offset:0
    v_mfma_f32_16x16x32_bf16 v[56:59], v[116:119], v[136:139], v[56:59]
    v_mfma_f32_16x16x32_bf16 v[64:67], v[120:123], v[136:139], v[64:67]
    ds_read_b64_tr_b16 v[176:177], v198 offset:12288
    v_mfma_f32_16x16x32_bf16 v[72:75], v[124:127], v[136:139], v[72:75]
    ds_read_b64_tr_b16 v[178:179], v198 offset:12800
    v_mfma_f32_16x16x32_bf16 v[76:79], v[124:127], v[140:143], v[76:79]
    ds_read_b128 v[156:159], v197 offset:2048
    v_mfma_f32_16x16x32_bf16 v[68:71], v[120:123], v[140:143], v[68:71]
    ds_read_b128 v[160:163], v197 offset:4096
    v_mfma_f32_16x16x32_bf16 v[60:63], v[116:119], v[140:143], v[60:63]
    ds_read_b128 v[164:167], v197 offset:6144
    v_mfma_f32_16x16x32_bf16 v[52:55], v[112:115], v[140:143], v[52:55]
    ds_read_b64_tr_b16 v[180:181], v199 offset:12288
    v_mfma_f32_16x16x32_bf16 v[80:83], v[112:115], v[144:147], v[80:83]
    ds_read_b64_tr_b16 v[182:183], v199 offset:12800
    v_mfma_f32_16x16x32_bf16 v[88:91], v[116:119], v[144:147], v[88:91]
    ds_read_b64_tr_b16 v[184:185], v198 offset:20480
    v_mfma_f32_16x16x32_bf16 v[96:99], v[120:123], v[144:147], v[96:99]
    v_mfma_f32_16x16x32_bf16 v[104:107], v[124:127], v[144:147], v[104:107]
    ds_read_b64_tr_b16 v[186:187], v198 offset:20992
    v_mfma_f32_16x16x32_bf16 v[108:111], v[124:127], v[148:151], v[108:111]
    ds_read_b64_tr_b16 v[188:189], v199 offset:20480
    v_mfma_f32_16x16x32_bf16 v[100:103], v[120:123], v[148:151], v[100:103]
    ds_read_b64_tr_b16 v[190:191], v199 offset:20992
    v_mfma_f32_16x16x32_bf16 v[92:95], v[116:119], v[148:151], v[92:95]
    ds_read_b64_tr_b16 v[168:169], v198 offset:4096
    v_mfma_f32_16x16x32_bf16 v[84:87], v[112:115], v[148:151], v[84:87]
    ds_read_b64_tr_b16 v[170:171], v198 offset:4608
    v_mfma_f32_16x16x32_bf16 v[16:19], v[128:131], v[112:115], v[16:19]
    ds_read_b64_tr_b16 v[172:173], v199 offset:4096
    v_mfma_f32_16x16x32_bf16 v[24:27], v[128:131], v[116:119], v[24:27]
    ds_read_b64_tr_b16 v[174:175], v199 offset:4608
    v_mfma_f32_16x16x32_bf16 v[32:35], v[128:131], v[120:123], v[32:35]
    v_mfma_f32_16x16x32_bf16 v[40:43], v[128:131], v[124:127], v[40:43]
    v_mfma_f32_16x16x32_bf16 v[44:47], v[132:135], v[124:127], v[44:47]
    v_mfma_f32_16x16x32_bf16 v[36:39], v[132:135], v[120:123], v[36:39]
    v_mfma_f32_16x16x32_bf16 v[28:31], v[132:135], v[116:119], v[28:31]
    s_waitcnt lgkmcnt(0)
    s_barrier
    v_mfma_f32_16x16x32_bf16 v[20:23], v[132:135], v[112:115], v[20:23]
    v_mfma_f32_16x16x32_bf16 v[48:51], v[152:155], v[176:179], v[48:51]
    ds_read_b128 v[112:115], v200 offset:0
    v_mfma_f32_16x16x32_bf16 v[56:59], v[156:159], v[176:179], v[56:59]
    v_mfma_f32_16x16x32_bf16 v[64:67], v[160:163], v[176:179], v[64:67]
    ds_read_b64_tr_b16 v[136:137], v202 offset:8192
    v_mfma_f32_16x16x32_bf16 v[72:75], v[164:167], v[176:179], v[72:75]
    ds_read_b64_tr_b16 v[138:139], v202 offset:8704
    v_mfma_f32_16x16x32_bf16 v[76:79], v[164:167], v[180:183], v[76:79]
    ds_read_b128 v[116:119], v200 offset:2048
    v_mfma_f32_16x16x32_bf16 v[68:71], v[160:163], v[180:183], v[68:71]
    ds_read_b128 v[120:123], v200 offset:4096
    v_mfma_f32_16x16x32_bf16 v[60:63], v[156:159], v[180:183], v[60:63]
    ds_read_b128 v[124:127], v200 offset:6144
    v_mfma_f32_16x16x32_bf16 v[52:55], v[152:155], v[180:183], v[52:55]
    ds_read_b64_tr_b16 v[140:141], v203 offset:8192
    v_mfma_f32_16x16x32_bf16 v[80:83], v[152:155], v[184:187], v[80:83]
    ds_read_b64_tr_b16 v[142:143], v203 offset:8704
    v_mfma_f32_16x16x32_bf16 v[88:91], v[156:159], v[184:187], v[88:91]
    ds_read_b64_tr_b16 v[144:145], v202 offset:16384
    v_mfma_f32_16x16x32_bf16 v[96:99], v[160:163], v[184:187], v[96:99]
    v_mfma_f32_16x16x32_bf16 v[104:107], v[164:167], v[184:187], v[104:107]
    ds_read_b64_tr_b16 v[146:147], v202 offset:16896
    v_mfma_f32_16x16x32_bf16 v[108:111], v[164:167], v[188:191], v[108:111]
    ds_read_b64_tr_b16 v[148:149], v203 offset:16384
    v_mfma_f32_16x16x32_bf16 v[100:103], v[160:163], v[188:191], v[100:103]
    ds_read_b64_tr_b16 v[150:151], v203 offset:16896
    v_mfma_f32_16x16x32_bf16 v[92:95], v[156:159], v[188:191], v[92:95]
    ds_read_b64_tr_b16 v[128:129], v202 offset:0
    v_mfma_f32_16x16x32_bf16 v[84:87], v[152:155], v[188:191], v[84:87]
    ds_read_b64_tr_b16 v[130:131], v202 offset:512
    v_mfma_f32_16x16x32_bf16 v[16:19], v[168:171], v[152:155], v[16:19]
    ds_read_b64_tr_b16 v[132:133], v203 offset:0
    v_mfma_f32_16x16x32_bf16 v[24:27], v[168:171], v[156:159], v[24:27]
    ds_read_b64_tr_b16 v[134:135], v203 offset:512
    v_mfma_f32_16x16x32_bf16 v[32:35], v[168:171], v[160:163], v[32:35]
    v_mfma_f32_16x16x32_bf16 v[40:43], v[168:171], v[164:167], v[40:43]
    v_mfma_f32_16x16x32_bf16 v[44:47], v[172:175], v[164:167], v[44:47]
    v_mfma_f32_16x16x32_bf16 v[36:39], v[172:175], v[160:163], v[36:39]
    v_mfma_f32_16x16x32_bf16 v[28:31], v[172:175], v[156:159], v[28:31]
    v_mfma_f32_16x16x32_bf16 v[20:23], v[172:175], v[152:155], v[20:23]
    s_waitcnt lgkmcnt(0)
    s_nop 0
    v_mfma_f32_16x16x32_bf16 v[48:51], v[112:115], v[136:139], v[48:51]
    ds_read_b128 v[152:155], v201 offset:0
    v_mfma_f32_16x16x32_bf16 v[56:59], v[116:119], v[136:139], v[56:59]
    v_mfma_f32_16x16x32_bf16 v[64:67], v[120:123], v[136:139], v[64:67]
    ds_read_b64_tr_b16 v[176:177], v202 offset:12288
    v_mfma_f32_16x16x32_bf16 v[72:75], v[124:127], v[136:139], v[72:75]
    ds_read_b64_tr_b16 v[178:179], v202 offset:12800
    v_mfma_f32_16x16x32_bf16 v[76:79], v[124:127], v[140:143], v[76:79]
    ds_read_b128 v[156:159], v201 offset:2048
    v_mfma_f32_16x16x32_bf16 v[68:71], v[120:123], v[140:143], v[68:71]
    ds_read_b128 v[160:163], v201 offset:4096
    v_mfma_f32_16x16x32_bf16 v[60:63], v[116:119], v[140:143], v[60:63]
    ds_read_b128 v[164:167], v201 offset:6144
    v_mfma_f32_16x16x32_bf16 v[52:55], v[112:115], v[140:143], v[52:55]
    ds_read_b64_tr_b16 v[180:181], v203 offset:12288
    v_mfma_f32_16x16x32_bf16 v[80:83], v[112:115], v[144:147], v[80:83]
    ds_read_b64_tr_b16 v[182:183], v203 offset:12800
    v_mfma_f32_16x16x32_bf16 v[88:91], v[116:119], v[144:147], v[88:91]
    ds_read_b64_tr_b16 v[184:185], v202 offset:20480
    v_mfma_f32_16x16x32_bf16 v[96:99], v[120:123], v[144:147], v[96:99]
    v_mfma_f32_16x16x32_bf16 v[104:107], v[124:127], v[144:147], v[104:107]
    ds_read_b64_tr_b16 v[186:187], v202 offset:20992
    v_mfma_f32_16x16x32_bf16 v[108:111], v[124:127], v[148:151], v[108:111]
    ds_read_b64_tr_b16 v[188:189], v203 offset:20480
    v_mfma_f32_16x16x32_bf16 v[100:103], v[120:123], v[148:151], v[100:103]
    ds_read_b64_tr_b16 v[190:191], v203 offset:20992
    v_mfma_f32_16x16x32_bf16 v[92:95], v[116:119], v[148:151], v[92:95]
    ds_read_b64_tr_b16 v[168:169], v202 offset:4096
    v_mfma_f32_16x16x32_bf16 v[84:87], v[112:115], v[148:151], v[84:87]
    ds_read_b64_tr_b16 v[170:171], v202 offset:4608
    v_mfma_f32_16x16x32_bf16 v[16:19], v[128:131], v[112:115], v[16:19]
    ds_read_b64_tr_b16 v[172:173], v203 offset:4096
    v_mfma_f32_16x16x32_bf16 v[24:27], v[128:131], v[116:119], v[24:27]
    ds_read_b64_tr_b16 v[174:175], v203 offset:4608
    v_mfma_f32_16x16x32_bf16 v[32:35], v[128:131], v[120:123], v[32:35]
    v_mfma_f32_16x16x32_bf16 v[40:43], v[128:131], v[124:127], v[40:43]
    v_mfma_f32_16x16x32_bf16 v[44:47], v[132:135], v[124:127], v[44:47]
    v_mfma_f32_16x16x32_bf16 v[36:39], v[132:135], v[120:123], v[36:39]
    v_mfma_f32_16x16x32_bf16 v[28:31], v[132:135], v[116:119], v[28:31]
    s_waitcnt lgkmcnt(0)
    s_barrier
    v_mfma_f32_16x16x32_bf16 v[20:23], v[132:135], v[112:115], v[20:23]
    v_mfma_f32_16x16x32_bf16 v[48:51], v[152:155], v[176:179], v[48:51]
    ds_read_b128 v[112:115], v192 offset:0
    v_mfma_f32_16x16x32_bf16 v[56:59], v[156:159], v[176:179], v[56:59]
    v_mfma_f32_16x16x32_bf16 v[64:67], v[160:163], v[176:179], v[64:67]
    ds_read_b64_tr_b16 v[136:137], v194 offset:8192
    v_mfma_f32_16x16x32_bf16 v[72:75], v[164:167], v[176:179], v[72:75]
    ds_read_b64_tr_b16 v[138:139], v194 offset:8704
    v_mfma_f32_16x16x32_bf16 v[76:79], v[164:167], v[180:183], v[76:79]
    ds_read_b128 v[116:119], v192 offset:2048
    v_mfma_f32_16x16x32_bf16 v[68:71], v[160:163], v[180:183], v[68:71]
    ds_read_b128 v[120:123], v192 offset:4096
    v_mfma_f32_16x16x32_bf16 v[60:63], v[156:159], v[180:183], v[60:63]
    ds_read_b128 v[124:127], v192 offset:6144
    v_mfma_f32_16x16x32_bf16 v[52:55], v[152:155], v[180:183], v[52:55]
    ds_read_b64_tr_b16 v[140:141], v195 offset:8192
    v_mfma_f32_16x16x32_bf16 v[80:83], v[152:155], v[184:187], v[80:83]
    ds_read_b64_tr_b16 v[142:143], v195 offset:8704
    v_mfma_f32_16x16x32_bf16 v[88:91], v[156:159], v[184:187], v[88:91]
    ds_read_b64_tr_b16 v[144:145], v194 offset:16384
    v_mfma_f32_16x16x32_bf16 v[96:99], v[160:163], v[184:187], v[96:99]
    v_mfma_f32_16x16x32_bf16 v[104:107], v[164:167], v[184:187], v[104:107]
    ds_read_b64_tr_b16 v[146:147], v194 offset:16896
    v_mfma_f32_16x16x32_bf16 v[108:111], v[164:167], v[188:191], v[108:111]
    ds_read_b64_tr_b16 v[148:149], v195 offset:16384
    v_mfma_f32_16x16x32_bf16 v[100:103], v[160:163], v[188:191], v[100:103]
    ds_read_b64_tr_b16 v[150:151], v195 offset:16896
    v_mfma_f32_16x16x32_bf16 v[92:95], v[156:159], v[188:191], v[92:95]
    ds_read_b64_tr_b16 v[128:129], v194 offset:0
    v_mfma_f32_16x16x32_bf16 v[84:87], v[152:155], v[188:191], v[84:87]
    ds_read_b64_tr_b16 v[130:131], v194 offset:512
    v_mfma_f32_16x16x32_bf16 v[16:19], v[168:171], v[152:155], v[16:19]
    ds_read_b64_tr_b16 v[132:133], v195 offset:0
    v_mfma_f32_16x16x32_bf16 v[24:27], v[168:171], v[156:159], v[24:27]
    ds_read_b64_tr_b16 v[134:135], v195 offset:512
    v_mfma_f32_16x16x32_bf16 v[32:35], v[168:171], v[160:163], v[32:35]
    v_mfma_f32_16x16x32_bf16 v[40:43], v[168:171], v[164:167], v[40:43]
    v_mfma_f32_16x16x32_bf16 v[44:47], v[172:175], v[164:167], v[44:47]
    v_mfma_f32_16x16x32_bf16 v[36:39], v[172:175], v[160:163], v[36:39]
    s_add_u32 s77, s77, 1
    s_cmp_lt_u32 s77, 5
    v_mfma_f32_16x16x32_bf16 v[28:31], v[172:175], v[156:159], v[28:31]
    v_mfma_f32_16x16x32_bf16 v[20:23], v[172:175], v[152:155], v[20:23]
    s_waitcnt lgkmcnt(0)
    s_cbranch_scc1 L_p1
    v_mfma_f32_16x16x32_bf16 v[48:51], v[112:115], v[136:139], v[48:51]
    ds_read_b128 v[152:155], v193 offset:0
    s_mul_i32 s76, s74, 63488
    v_mfma_f32_16x16x32_bf16 v[56:59], v[116:119], v[136:139], v[56:59]
    ds_read_b64_tr_b16 v[176:177], v194 offset:12288
    s_add_u32 s76, s76, 36864
    v_mfma_f32_16x16x32_bf16 v[64:67], v[120:123], v[136:139], v[64:67]
    ds_read_b64_tr_b16 v[178:179], v194 offset:12800
    s_lshl_b32 s68, s73, 11
    v_mfma_f32_16x16x32_bf16 v[72:75], v[124:127], v[136:139], v[72:75]
    ds_read_b128 v[156:159], v193 offset:2048
    ds_read_b128 v[160:163], v193 offset:4096
    v_mfma_f32_16x16x32_bf16 v[76:79], v[124:127], v[140:143], v[76:79]
    ds_read_b128 v[164:167], v193 offset:6144
    s_add_u32 s69, s68, s76
    v_mfma_f32_16x16x32_bf16 v[68:71], v[120:123], v[140:143], v[68:71]
    ds_read_b64_tr_b16 v[180:181], v195 offset:12288
    ds_read_b64_tr_b16 v[182:183], v195 offset:12800
    v_mfma_f32_16x16x32_bf16 v[60:63], v[116:119], v[140:143], v[60:63]
    ds_read_b64_tr_b16 v[184:185], v194 offset:20480
    s_xor_b32 s68, s68, 2048
    v_mfma_f32_16x16x32_bf16 v[52:55], v[112:115], v[140:143], v[52:55]
    ds_read_b64_tr_b16 v[186:187], v194 offset:20992
    ds_read_b64_tr_b16 v[188:189], v195 offset:20480
    v_mfma_f32_16x16x32_bf16 v[80:83], v[112:115], v[144:147], v[80:83]
    ds_read_b64_tr_b16 v[190:191], v195 offset:20992
    s_add_u32 s68, s68, s76
    s_nop 0
    v_mfma_f32_16x16x32_bf16 v[88:91], v[116:119], v[144:147], v[88:91]
    ds_read_b64_tr_b16 v[168:169], v194 offset:4096
    ds_read_b64_tr_b16 v[170:171], v194 offset:4608
    v_mfma_f32_16x16x32_bf16 v[96:99], v[120:123], v[144:147], v[96:99]
    ds_read_b64_tr_b16 v[172:173], v195 offset:4096
    s_mov_b32 s72, 897988541
    v_mfma_f32_16x16x32_bf16 v[104:107], v[124:127], v[144:147], v[104:107]
    ds_read_b64_tr_b16 v[174:175], v195 offset:4608
    s_mov_b32 s71, s70
    v_mfma_f32_16x16x32_bf16 v[108:111], v[124:127], v[148:151], v[108:111]
    v_mfma_f32_16x16x32_bf16 v[100:103], v[120:123], v[148:151], v[100:103]
    v_mfma_f32_16x16x32_bf16 v[92:95], v[116:119], v[148:151], v[92:95]
    v_mfma_f32_16x16x32_bf16 v[84:87], v[112:115], v[148:151], v[84:87]
    s_waitcnt lgkmcnt(0)
    s_nop 0
    v_mfma_f32_16x16x32_bf16 v[48:51], v[152:155], v[176:179], v[48:51]
    v_mov_b32 v204, 3216550459
    v_mov_b32 v205, 3216550459
    v_mfma_f32_16x16x32_bf16 v[56:59], v[156:159], v[176:179], v[56:59]
    v_mov_b32 v196, s72
    v_mov_b32_e64 v197, s72
    v_mfma_f32_16x16x32_bf16 v[64:67], v[160:163], v[176:179], v[64:67]
    v_add_u32 v2, s69, v15
    v_add_u32 v3, s68, v15
    v_mfma_f32_16x16x32_bf16 v[72:75], v[164:167], v[176:179], v[72:75]
    s_lshl_b32 s68, s66, 2
    v_mov_b32 v4, s68
    v_mfma_f32_16x16x32_bf16 v[76:79], v[164:167], v[180:183], v[76:79]
    v_mov_b32 v6, 1
    v_xor_b32 v5, 4, v4
    v_mfma_f32_16x16x32_bf16 v[68:71], v[160:163], v[180:183], v[68:71]
    v_mov_b32 v248, 0x3f803f80
    v_mov_b32 v249, 0x3f803f80
    v_mfma_f32_16x16x32_bf16 v[60:63], v[156:159], v[180:183], v[60:63]
    v_mov_b32 v250, 0x3f803f80
    v_mov_b32 v251, 0x3f803f80
    v_mfma_f32_16x16x32_bf16 v[52:55], v[152:155], v[180:183], v[52:55]
    s_lshl_b32 s68, s75, 5
    s_lshl_b32 s69, s63, 1
    v_mfma_f32_16x16x32_bf16 v[80:83], v[152:155], v[184:187], v[80:83]
    s_add_u32 s69, s69, s73
    s_add_u32 s68, s68, s69
    v_mfma_f32_16x16x32_bf16 v[88:91], v[156:159], v[184:187], v[88:91]
    s_lshl_b32 s68, s68, 6
    s_add_u32 s78, s68, 262144
    v_mfma_f32_16x16x32_bf16 v[96:99], v[160:163], v[184:187], v[96:99]
    s_lshl_b32 s68, s75, 1
    s_add_u32 s68, s68, s73
    v_mfma_f32_16x16x32_bf16 v[104:107], v[164:167], v[184:187], v[104:107]
    s_lshl_b32 s79, s68, 14
    s_add_u32 s79, s79, 1048576
    v_mfma_f32_16x16x32_bf16 v[108:111], v[164:167], v[188:191], v[108:111]
    s_lshl_b32 s68, s63, 10
    s_add_u32 s80, s68, s79
    v_mfma_f32_16x16x32_bf16 v[100:103], v[160:163], v[188:191], v[100:103]
    v_mfma_f32_16x16x32_bf16 v[92:95], v[156:159], v[188:191], v[92:95]
    v_mfma_f32_16x16x32_bf16 v[84:87], v[152:155], v[188:191], v[84:87]
    v_pk_fma_f32 v[192:193], v[48:49], s[70:71], v[204:205]
    v_exp_f32 v192, v192 clamp
    v_exp_f32 v193, v193 clamp
    v_max_f32 v192, v192, v48
    v_max_f32 v193, v193, v49
    v_pk_add_f32 v[192:193], v[192:193], v[196:197]
    v_cvt_pk_bf16_f32 v136, v192, v193
    v_pk_fma_f32 v[194:195], v[50:51], s[70:71], v[204:205]
    v_exp_f32 v194, v194 clamp
    v_exp_f32 v195, v195 clamp
    v_max_f32 v194, v194, v50
    v_max_f32 v195, v195, v51
    v_pk_add_f32 v[194:195], v[194:195], v[196:197]
    v_cvt_pk_bf16_f32 v137, v194, v195
    v_pk_fma_f32 v[192:193], v[56:57], s[70:71], v[204:205]
    v_exp_f32 v192, v192 clamp
    v_exp_f32 v193, v193 clamp
    v_max_f32 v192, v192, v56
    v_max_f32 v193, v193, v57
    v_pk_add_f32 v[192:193], v[192:193], v[196:197]
    v_cvt_pk_bf16_f32 v138, v192, v193
    v_pk_fma_f32 v[194:195], v[58:59], s[70:71], v[204:205]
    v_exp_f32 v194, v194 clamp
    v_exp_f32 v195, v195 clamp
    v_max_f32 v194, v194, v58
    v_max_f32 v195, v195, v59
    v_pk_add_f32 v[194:195], v[194:195], v[196:197]
    v_cvt_pk_bf16_f32 v139, v194, v195
    v_pk_fma_f32 v[192:193], v[52:53], s[70:71], v[204:205]
    v_exp_f32 v192, v192 clamp
    v_exp_f32 v193, v193 clamp
    v_max_f32 v192, v192, v52
    v_max_f32 v193, v193, v53
    v_pk_add_f32 v[192:193], v[192:193], v[196:197]
    v_cvt_pk_bf16_f32 v140, v192, v193
    v_pk_fma_f32 v[194:195], v[54:55], s[70:71], v[204:205]
    v_exp_f32 v194, v194 clamp
    v_exp_f32 v195, v195 clamp
    v_max_f32 v194, v194, v54
    v_max_f32 v195, v195, v55
    v_pk_add_f32 v[194:195], v[194:195], v[196:197]
    v_cvt_pk_bf16_f32 v141, v194, v195
    v_pk_fma_f32 v[192:193], v[60:61], s[70:71], v[204:205]
    v_exp_f32 v192, v192 clamp
    v_exp_f32 v193, v193 clamp
    v_max_f32 v192, v192, v60
    v_max_f32 v193, v193, v61
    v_pk_add_f32 v[192:193], v[192:193], v[196:197]
    v_cvt_pk_bf16_f32 v142, v192, v193
    v_pk_fma_f32 v[194:195], v[62:63], s[70:71], v[204:205]
    v_exp_f32 v194, v194 clamp
    v_exp_f32 v195, v195 clamp
    v_max_f32 v194, v194, v62
    v_max_f32 v195, v195, v63
    v_pk_add_f32 v[194:195], v[194:195], v[196:197]
    v_cvt_pk_bf16_f32 v143, v194, v195
    v_pk_fma_f32 v[192:193], v[64:65], s[70:71], v[204:205]
    v_exp_f32 v192, v192 clamp
    v_exp_f32 v193, v193 clamp
    v_max_f32 v192, v192, v64
    v_max_f32 v193, v193, v65
    v_pk_add_f32 v[192:193], v[192:193], v[196:197]
    v_cvt_pk_bf16_f32 v144, v192, v193
    v_pk_fma_f32 v[194:195], v[66:67], s[70:71], v[204:205]
    v_exp_f32 v194, v194 clamp
    v_exp_f32 v195, v195 clamp
    v_max_f32 v194, v194, v66
    v_max_f32 v195, v195, v67
    v_pk_add_f32 v[194:195], v[194:195], v[196:197]
    v_cvt_pk_bf16_f32 v145, v194, v195
    v_pk_fma_f32 v[192:193], v[72:73], s[70:71], v[204:205]
    v_exp_f32 v192, v192 clamp
    v_exp_f32 v193, v193 clamp
    v_max_f32 v192, v192, v72
    v_max_f32 v193, v193, v73
    v_pk_add_f32 v[192:193], v[192:193], v[196:197]
    v_cvt_pk_bf16_f32 v146, v192, v193
    v_pk_fma_f32 v[194:195], v[74:75], s[70:71], v[204:205]
    v_exp_f32 v194, v194 clamp
    v_exp_f32 v195, v195 clamp
    v_max_f32 v194, v194, v74
    v_max_f32 v195, v195, v75
    v_pk_add_f32 v[194:195], v[194:195], v[196:197]
    v_cvt_pk_bf16_f32 v147, v194, v195
    v_pk_fma_f32 v[192:193], v[68:69], s[70:71], v[204:205]
    v_exp_f32 v192, v192 clamp
    v_exp_f32 v193, v193 clamp
    v_max_f32 v192, v192, v68
    v_max_f32 v193, v193, v69
    v_pk_add_f32 v[192:193], v[192:193], v[196:197]
    v_cvt_pk_bf16_f32 v148, v192, v193
    v_pk_fma_f32 v[194:195], v[70:71], s[70:71], v[204:205]
    v_exp_f32 v194, v194 clamp
    v_exp_f32 v195, v195 clamp
    v_max_f32 v194, v194, v70
    v_max_f32 v195, v195, v71
    v_pk_add_f32 v[194:195], v[194:195], v[196:197]
    v_cvt_pk_bf16_f32 v149, v194, v195
    v_pk_fma_f32 v[192:193], v[76:77], s[70:71], v[204:205]
    v_exp_f32 v192, v192 clamp
    v_exp_f32 v193, v193 clamp
    v_max_f32 v192, v192, v76
    v_max_f32 v193, v193, v77
    v_pk_add_f32 v[192:193], v[192:193], v[196:197]
    v_cvt_pk_bf16_f32 v150, v192, v193
    v_pk_fma_f32 v[194:195], v[78:79], s[70:71], v[204:205]
    v_exp_f32 v194, v194 clamp
    v_exp_f32 v195, v195 clamp
    v_max_f32 v194, v194, v78
    v_max_f32 v195, v195, v79
    v_pk_add_f32 v[194:195], v[194:195], v[196:197]
    v_cvt_pk_bf16_f32 v151, v194, v195
    v_mfma_f32_16x16x32_bf16 v[224:227], v[136:139], v[248:251], 0
    v_cvt_pk_bf16_f32 v232, v80, v81
    v_cvt_pk_bf16_f32 v233, v82, v83
    v_mfma_f32_16x16x32_bf16 v[228:231], v[140:143], v[248:251], 0
    v_cvt_pk_bf16_f32 v234, v88, v89
    v_cvt_pk_bf16_f32 v235, v90, v91
    v_mfma_f32_16x16x32_bf16 v[224:227], v[144:147], v[248:251], v[224:227]
    v_cvt_pk_bf16_f32 v236, v84, v85
    v_cvt_pk_bf16_f32 v237, v86, v87
    v_mfma_f32_16x16x32_bf16 v[228:231], v[148:151], v[248:251], v[228:231]
    v_cvt_pk_bf16_f32 v238, v92, v93
    v_cvt_pk_bf16_f32 v239, v94, v95
    v_mfma_f32_16x16x32_bf16 v[208:211], v[136:139], v[232:235], 0
    v_cvt_pk_bf16_f32 v240, v96, v97
    v_cvt_pk_bf16_f32 v241, v98, v99
    v_mfma_f32_16x16x32_bf16 v[212:215], v[140:143], v[232:235], 0
    v_cvt_pk_bf16_f32 v242, v104, v105
    v_cvt_pk_bf16_f32 v243, v106, v107
    v_mfma_f32_16x16x32_bf16 v[216:219], v[136:139], v[236:239], 0
    v_cvt_pk_bf16_f32 v244, v100, v101
    v_cvt_pk_bf16_f32 v245, v102, v103
    v_mfma_f32_16x16x32_bf16 v[220:223], v[140:143], v[236:239], 0
    v_cvt_pk_bf16_f32 v246, v108, v109
    v_cvt_pk_bf16_f32 v247, v110, v111
    v_mfma_f32_16x16x32_bf16 v[208:211], v[144:147], v[240:243], v[208:211]
    v_mfma_f32_16x16x32_bf16 v[212:215], v[148:151], v[240:243], v[212:215]
    v_mfma_f32_16x16x32_bf16 v[216:219], v[144:147], v[244:247], v[216:219]
    v_mfma_f32_16x16x32_bf16 v[220:223], v[148:151], v[244:247], v[220:223]
    v_cvt_pk_bf16_f32 v176, v224, v225
    v_cvt_pk_bf16_f32 v177, v226, v227
    v_cvt_pk_bf16_f32 v178, v228, v229
    v_cvt_pk_bf16_f32 v179, v230, v231
    s_mov_b32 exec_lo, 0x10001
    s_mov_b32 exec_hi, 0x10001
    buffer_store_dwordx4 v[176:179], v0, s[52:55], s78 offen sc1
    s_mov_b64 exec, -1
    s_cmp_eq_u32 s73, 0
    s_cbranch_scc1 L_ex0
    s_nop 0
    ds_write_b128 v2, v[208:211]
    ds_write_b128 v2, v[212:215] offset:1024
    ds_write_b32 v4, v6
    s_mov_b32 s69, 3200000
fpoll_1:
    ds_read_b32 v14, v5
    ds_read_b128 v[184:187], v3
    ds_read_b128 v[188:191], v3 offset:1024
    s_waitcnt lgkmcnt(0)
    v_cmp_ne_u32 vcc, 0, v14
    s_cbranch_vccnz fpolld_2
    s_sub_u32 s69, s69, 1
    s_cmp_lg_u32 s69, 0
    s_cbranch_scc1 fpoll_1
fpolld_2:
    v_add_f32 v216, v216, v184
    v_add_f32 v217, v217, v185
    v_cvt_pk_bf16_f32 v180, v216, v217
    v_add_f32 v218, v218, v186
    v_add_f32 v219, v219, v187
    v_cvt_pk_bf16_f32 v181, v218, v219
    v_add_f32 v220, v220, v188
    v_add_f32 v221, v221, v189
    v_cvt_pk_bf16_f32 v182, v220, v221
    v_add_f32 v222, v222, v190
    v_add_f32 v223, v223, v191
    v_cvt_pk_bf16_f32 v183, v222, v223
    s_branch L_exd
L_ex0:
    s_nop 0
    ds_write_b128 v2, v[216:219]
    ds_write_b128 v2, v[220:223] offset:1024
    ds_write_b32 v4, v6
    s_mov_b32 s69, 3200000
fpoll_3:
    ds_read_b32 v14, v5
    ds_read_b128 v[184:187], v3
    ds_read_b128 v[188:191], v3 offset:1024
    s_waitcnt lgkmcnt(0)
    v_cmp_ne_u32 vcc, 0, v14
    s_cbranch_vccnz fpolld_4
    s_sub_u32 s69, s69, 1
    s_cmp_lg_u32 s69, 0
    s_cbranch_scc1 fpoll_3
fpolld_4:
    v_add_f32 v208, v208, v184
    v_add_f32 v209, v209, v185
    v_cvt_pk_bf16_f32 v180, v208, v209
    v_add_f32 v210, v210, v186
    v_add_f32 v211, v211, v187
    v_cvt_pk_bf16_f32 v181, v210, v211
    v_add_f32 v212, v212, v188
    v_add_f32 v213, v213, v189
    v_cvt_pk_bf16_f32 v182, v212, v213
    v_add_f32 v214, v214, v190
    v_add_f32 v215, v215, v191
    v_cvt_pk_bf16_f32 v183, v214, v215
L_exd:
    buffer_store_dwordx4 v[180:183], v15, s[52:55], s80 offen sc1
    v_mfma_f32_16x16x32_bf16 v[16:19], v[128:131], v[112:115], v[16:19]
    v_mov_b32 v255, 0x3f80
    v_mov_b32_e64 v207, 0x3f800000
    v_mfma_f32_16x16x32_bf16 v[24:27], v[128:131], v[116:119], v[24:27]
    v_cmp_eq_u32_e64 vcc, 0, v206
    v_cmp_eq_u32 s[4:5], 1, v206
    v_mfma_f32_16x16x32_bf16 v[32:35], v[128:131], v[120:123], v[32:35]
    v_cndmask_b32_e64 v8, 0, v255, vcc
    v_cndmask_b32 v8, v8, v207, s[4:5]
    v_mfma_f32_16x16x32_bf16 v[40:43], v[128:131], v[124:127], v[40:43]
    v_cmp_eq_u32_e64 vcc, 2, v206
    v_cmp_eq_u32 s[4:5], 3, v206
    v_mfma_f32_16x16x32_bf16 v[44:47], v[132:135], v[124:127], v[44:47]
    v_cndmask_b32_e64 v9, 0, v255, vcc
    v_cndmask_b32 v9, v9, v207, s[4:5]
    v_mfma_f32_16x16x32_bf16 v[36:39], v[132:135], v[120:123], v[36:39]
    v_mov_b32 v12, v8
    v_mov_b32 v13, v9
    v_mfma_f32_16x16x32_bf16 v[28:31], v[132:135], v[116:119], v[28:31]
    v_mfma_f32_16x16x32_bf16 v[20:23], v[132:135], v[112:115], v[20:23]
    v_mfma_f32_16x16x32_bf16 v[16:19], v[168:171], v[152:155], v[16:19]
    v_mfma_f32_16x16x32_bf16 v[24:27], v[168:171], v[156:159], v[24:27]
    v_mfma_f32_16x16x32_bf16 v[32:35], v[168:171], v[160:163], v[32:35]
    v_mfma_f32_16x16x32_bf16 v[40:43], v[168:171], v[164:167], v[40:43]
    v_mfma_f32_16x16x32_bf16 v[44:47], v[172:175], v[164:167], v[44:47]
    v_mfma_f32_16x16x32_bf16 v[36:39], v[172:175], v[160:163], v[36:39]
    v_mfma_f32_16x16x32_bf16 v[28:31], v[172:175], v[156:159], v[28:31]
    v_mfma_f32_16x16x32_bf16 v[20:23], v[172:175], v[152:155], v[20:23]
    s_lshl_b32 s68, s73, 10
    v_add_u32 v3, s76, v15
    v_add_u32 v206, s68, v3
    v_add_u32_e64 v5, 16, v5
    s_lshl_b32 s68, s63, 1
    s_add_u32 s68, s68, s73
    s_lshl_b32 s80, s68, 17
    s_lshl_b32 s68, s75, 10
    s_add_u32 s80, s80, s68
    s_add_u32 s80, s80, 4194304
    s_lshl_b32 s78, s75, 11
    s_add_u32 s78, s78, 262144
    s_lshl_b32 s81, s63, 11
    v_fma_f32 v192, v16, s70, v204
    v_fma_f32 v193, v17, s70, v204
    v_exp_f32 v192, v192 clamp
    v_exp_f32 v193, v193 clamp
    v_max_f32 v192, v192, v16
    v_max_f32 v193, v193, v17
    v_add_f32 v192, s72, v192
    v_add_f32 v193, s72, v193
    v_cvt_pk_bf16_f32 v48, v192, v193
    v_fma_f32 v194, v18, s70, v204
    v_fma_f32 v195, v19, s70, v204
    v_exp_f32 v194, v194 clamp
    v_exp_f32 v195, v195 clamp
    v_max_f32 v194, v194, v18
    v_max_f32 v195, v195, v19
    v_add_f32 v194, s72, v194
    v_add_f32 v195, s72, v195
    v_cvt_pk_bf16_f32 v49, v194, v195
    v_fma_f32 v192, v20, s70, v204
    v_fma_f32 v193, v21, s70, v204
    v_exp_f32 v192, v192 clamp
    v_exp_f32 v193, v193 clamp
    v_max_f32 v192, v192, v20
    v_max_f32 v193, v193, v21
    v_add_f32 v192, s72, v192
    v_add_f32 v193, s72, v193
    v_cvt_pk_bf16_f32 v50, v192, v193
    s_waitcnt vmcnt(0)
    v_mov_b32 v2, 64
    v_mov_b32 v14, 1
    s_mov_b64 exec, 1
    ds_add_rtn_u32 v14, v2, v14
    s_mov_b64 exec, -1
    s_lshl_b32 s68, s62, 11
    s_add_u32 s68, s68, 0
    s_waitcnt lgkmcnt(0)
    v_readfirstlane_b32 s77, v14
    s_mov_b32 s3, 1
    s_nop 1
    s_cmp_eq_u32 s77, 3
    s_cbranch_scc0 notlast_5
    s_atomic_add s3, s[32:33], s68
notlast_5:
    v_fma_f32 v194, v22, s70, v204
    v_fma_f32 v195, v23, s70, v204
    v_exp_f32 v194, v194 clamp
    v_exp_f32 v195, v195 clamp
    v_max_f32 v194, v194, v22
    v_max_f32 v195, v195, v23
    v_add_f32 v194, s72, v194
    v_add_f32_e64 v195, s72, v195
    v_cvt_pk_bf16_f32 v51, v194, v195
    v_fma_f32 v192, v24, s70, v204
    v_fma_f32 v193, v25, s70, v204
    v_exp_f32 v192, v192 clamp
    v_exp_f32 v193, v193 clamp
    v_max_f32 v192, v192, v24
    v_max_f32 v193, v193, v25
    v_add_f32 v192, s72, v192
    v_add_f32 v193, s72, v193
    v_cvt_pk_bf16_f32 v52, v192, v193
    v_fma_f32 v194, v26, s70, v204
    v_fma_f32 v195, v27, s70, v204
    v_exp_f32 v194, v194 clamp
    v_exp_f32 v195, v195 clamp
    v_max_f32 v194, v194, v26
    v_max_f32 v195, v195, v27
    v_add_f32 v194, s72, v194
    v_add_f32 v195, s72, v195
    v_cvt_pk_bf16_f32 v53, v194, v195
    v_fma_f32 v192, v28, s70, v204
    v_fma_f32 v193, v29, s70, v204
    v_exp_f32 v192, v192 clamp
    v_exp_f32 v193, v193 clamp
    v_max_f32 v192, v192, v28
    v_max_f32 v193, v193, v29
    v_add_f32 v192, s72, v192
    v_add_f32 v193, s72, v193
    v_cvt_pk_bf16_f32 v54, v192, v193
    v_fma_f32 v194, v30, s70, v204
    v_fma_f32 v195, v31, s70, v204
    v_exp_f32 v194, v194 clamp
    v_exp_f32 v195, v195 clamp
    v_max_f32 v194, v194, v30
    v_max_f32 v195, v195, v31
    v_add_f32 v194, s72, v194
    v_add_f32 v195, s72, v195
    v_cvt_pk_bf16_f32 v55, v194, v195
    v_fma_f32 v192, v32, s70, v204
    v_fma_f32 v193, v33, s70, v204
    v_exp_f32 v192, v192 clamp
    v_exp_f32 v193, v193 clamp
    v_max_f32 v192, v192, v32
    v_max_f32 v193, v193, v33
    v_add_f32 v192, s72, v192
    v_add_f32 v193, s72, v193
    v_cvt_pk_bf16_f32 v56, v192, v193
    v_fma_f32 v194, v34, s70, v204
    v_fma_f32 v195, v35, s70, v204
    v_exp_f32 v194, v194 clamp
    v_exp_f32 v195, v195 clamp
    v_max_f32 v194, v194, v34
    v_max_f32 v195, v195, v35
    v_add_f32 v194, s72, v194
    v_add_f32 v195, s72, v195
    v_cvt_pk_bf16_f32 v57, v194, v195
    v_fma_f32 v192, v36, s70, v204
    v_fma_f32 v193, v37, s70, v204
    v_exp_f32 v192, v192 clamp
    v_exp_f32 v193, v193 clamp
    v_max_f32 v192, v192, v36
    v_max_f32 v193, v193, v37
    v_add_f32 v192, s72, v192
    v_add_f32 v193, s72, v193
    v_cvt_pk_bf16_f32 v58, v192, v193
    v_fma_f32 v194, v38, s70, v204
    v_fma_f32 v195, v39, s70, v204
    v_exp_f32 v194, v194 clamp
    v_exp_f32 v195, v195 clamp
    v_max_f32 v194, v194, v38
    v_max_f32 v195, v195, v39
    v_add_f32 v194, s72, v194
    v_add_f32 v195, s72, v195
    v_cvt_pk_bf16_f32 v59, v194, v195
    v_fma_f32 v192, v40, s70, v204
    v_fma_f32 v193, v41, s70, v204
    v_exp_f32 v192, v192 clamp
    v_exp_f32 v193, v193 clamp
    v_max_f32 v192, v192, v40
    v_max_f32 v193, v193, v41
    v_add_f32 v192, s72, v192
    v_add_f32 v193, s72, v193
    v_cvt_pk_bf16_f32 v60, v192, v193
    v_fma_f32 v194, v42, s70, v204
    v_fma_f32 v195, v43, s70, v204
    v_exp_f32 v194, v194 clamp
    v_exp_f32 v195, v195 clamp
    v_max_f32 v194, v194, v42
    v_max_f32 v195, v195, v43
    v_add_f32 v194, s72, v194
    v_add_f32 v195, s72, v195
    v_cvt_pk_bf16_f32 v61, v194, v195
    v_fma_f32 v192, v44, s70, v204
    v_fma_f32 v193, v45, s70, v204
    v_exp_f32 v192, v192 clamp
    v_exp_f32 v193, v193 clamp
    v_max_f32 v192, v192, v44
    v_max_f32 v193, v193, v45
    v_add_f32 v192, s72, v192
    v_add_f32 v193, s72, v193
    v_cvt_pk_bf16_f32 v62, v192, v193
    v_fma_f32 v194, v46, s70, v204
    v_fma_f32 v195, v47, s70, v204
    v_exp_f32 v194, v194 clamp
    v_exp_f32 v195, v195 clamp
    v_max_f32 v194, v194, v46
    v_max_f32 v195, v195, v47
    v_add_f32 v194, s72, v194
    v_add_f32 v195, s72, v195
    v_cvt_pk_bf16_f32 v63, v194, v195
    s_cmp_eq_u32 s77, 3
    s_cbranch_scc0 follow_6
    s_mov_b64 exec, 1
    s_lshl_b32 s68, s62, 11
    s_add_u32 s68, s68, 0
    v_lshlrev_b32 v2, 7, v0
    s_mov_b32 s22, 400000
    s_waitcnt lgkmcnt(0)
gp_7:
    buffer_load_dword v14, v2, s[52:55], s68 offen sc1
    s_waitcnt vmcnt(0)
    v_cmp_eq_u32_e64 vcc, 16, v14
    s_cbranch_vccnz gpd_8
    s_sub_u32 s22, s22, 1
    s_cmp_lg_u32 s22, 0
    s_cbranch_scc1 gp_7
gpd_8:
    v_mov_b32 v2, 68
    v_mov_b32_e64 v14, 1
    ds_write_b32 v2, v14
    s_mov_b64 exec, -1
    s_branch gpe_9
follow_6:
    v_mov_b32 v2, 68
    s_mov_b32 s69, 3200000
lpoll_10:
    ds_read_b32 v14, v2 offset:0
    s_waitcnt lgkmcnt(0)
    v_cmp_ne_u32 vcc, 0, v14
    s_cmp_eq_u64 vcc, -1
    s_cbranch_scc1 lpolld_11
    s_sleep 1
    s_sub_u32 s69, s69, 1
    s_cmp_lg_u32 s69, 0
    s_cbranch_scc1 lpoll_10
lpolld_11:
gpe_9:
    buffer_load_dwordx4 v[72:75], v254, s[52:55], s78 offen sc1
    buffer_load_dwordx4 v[76:79], v254, s[52:55], s78 offen offset:1024 sc1
    s_and_b32 s81, s81, 0x3fff
    s_add_u32 s68, s81, s79
    buffer_load_dwordx4 v[80:83], v15, s[52:55], s68 offen sc1
    buffer_load_dwordx4 v[84:87], v15, s[52:55], s68 offen offset:1024 sc1
    s_add_u32 s81, s81, 2048
    s_and_b32 s81, s81, 0x3fff
    s_add_u32 s68, s81, s79
    buffer_load_dwordx4 v[88:91], v15, s[52:55], s68 offen sc1
    buffer_load_dwordx4 v[92:95], v15, s[52:55], s68 offen offset:1024 sc1
    s_add_u32 s81, s81, 2048
    s_and_b32 s81, s81, 0x3fff
    s_add_u32 s68, s81, s79
    buffer_load_dwordx4 v[96:99], v15, s[52:55], s68 offen sc1
    buffer_load_dwordx4 v[100:103], v15, s[52:55], s68 offen offset:1024 sc1
    s_add_u32 s81, s81, 2048
    s_and_b32 s81, s81, 0x3fff
    s_add_u32 s68, s81, s79
    buffer_load_dwordx4 v[104:107], v15, s[52:55], s68 offen sc1
    buffer_load_dwordx4 v[108:111], v15, s[52:55], s68 offen offset:1024 sc1
    s_add_u32 s81, s81, 2048
    s_and_b32 s81, s81, 0x3fff
    s_add_u32 s68, s81, s79
    buffer_load_dwordx4 v[112:115], v15, s[52:55], s68 offen sc1
    buffer_load_dwordx4 v[116:119], v15, s[52:55], s68 offen offset:1024 sc1
    s_add_u32 s81, s81, 2048
    s_and_b32 s81, s81, 0x3fff
    s_add_u32 s68, s81, s79
    buffer_load_dwordx4 v[120:123], v15, s[52:55], s68 offen sc1
    buffer_load_dwordx4 v[124:127], v15, s[52:55], s68 offen offset:1024 sc1
    s_add_u32 s81, s81, 2048
    s_and_b32 s81, s81, 0x3fff
    s_add_u32 s68, s81, s79
    buffer_load_dwordx4 v[128:131], v15, s[52:55], s68 offen sc1
    buffer_load_dwordx4 v[132:135], v15, s[52:55], s68 offen offset:1024 sc1
    s_add_u32 s81, s81, 2048
    s_and_b32 s81, s81, 0x3fff
    s_add_u32 s68, s81, s79
    buffer_load_dwordx4 v[136:139], v15, s[52:55], s68 offen sc1
    buffer_load_dwordx4 v[140:143], v15, s[52:55], s68 offen offset:1024 sc1
    s_add_u32 s81, s81, 2048
    s_waitcnt vmcnt(16)
    s_nop 0
    v_mfma_f32_16x16x32_bf16 v[176:179], v[72:75], v[48:51], 0
    v_mfma_f32_16x16x32_bf16 v[180:183], v[72:75], v[52:55], 0
    v_mfma_f32_16x16x32_bf16 v[184:187], v[72:75], v[56:59], 0
    v_mfma_f32_16x16x32_bf16 v[188:191], v[72:75], v[60:63], 0
    v_mfma_f32_16x16x32_bf16 v[176:179], v[76:79], v[48:51], v[176:179]
    v_mfma_f32_16x16x32_bf16 v[180:183], v[76:79], v[52:55], v[180:183]
    v_mfma_f32_16x16x32_bf16 v[184:187], v[76:79], v[56:59], v[184:187]
    v_mfma_f32_16x16x32_bf16 v[188:191], v[76:79], v[60:63], v[188:191]
    s_waitcnt vmcnt(15)
    v_mfma_f32_16x16x32_bf16 v[160:163], v[8:11], v[80:83], 0
    v_mfma_f32_16x16x32_bf16 v[164:167], v[10:13], v[80:83], 0
    s_waitcnt vmcnt(14)
    v_mfma_f32_16x16x32_bf16 v[160:163], v[8:11], v[84:87], v[160:163]
    v_mfma_f32_16x16x32_bf16 v[164:167], v[10:13], v[84:87], v[164:167]
    s_waitcnt vmcnt(13)
    v_mfma_f32_16x16x32_bf16 v[160:163], v[8:11], v[88:91], v[160:163]
    v_mfma_f32_16x16x32_bf16 v[164:167], v[10:13], v[88:91], v[164:167]
    s_waitcnt vmcnt(12)
    v_mfma_f32_16x16x32_bf16 v[160:163], v[8:11], v[92:95], v[160:163]
    v_mfma_f32_16x16x32_bf16 v[164:167], v[10:13], v[92:95], v[164:167]
    s_waitcnt vmcnt(11)
    v_mfma_f32_16x16x32_bf16 v[160:163], v[8:11], v[96:99], v[160:163]
    v_mfma_f32_16x16x32_bf16 v[164:167], v[10:13], v[96:99], v[164:167]
    s_waitcnt vmcnt(10)
    v_mfma_f32_16x16x32_bf16 v[160:163], v[8:11], v[100:103], v[160:163]
    v_mfma_f32_16x16x32_bf16 v[164:167], v[10:13], v[100:103], v[164:167]
    s_waitcnt vmcnt(9)
    v_mfma_f32_16x16x32_bf16 v[160:163], v[8:11], v[104:107], v[160:163]
    v_mfma_f32_16x16x32_bf16 v[164:167], v[10:13], v[104:107], v[164:167]
    v_add_f32 v176, v176, v177
    v_add_f32 v178, v178, v179
    s_waitcnt vmcnt(8)
    v_mfma_f32_16x16x32_bf16 v[160:163], v[8:11], v[108:111], v[160:163]
    v_mfma_f32_16x16x32_bf16 v[164:167], v[10:13], v[108:111], v[164:167]
    v_add_f32 v176, v176, v178
    v_add_f32_e64 v180, v180, v181
    s_waitcnt vmcnt(7)
    v_mfma_f32_16x16x32_bf16 v[160:163], v[8:11], v[112:115], v[160:163]
    v_mfma_f32_16x16x32_bf16 v[164:167], v[10:13], v[112:115], v[164:167]
    v_add_f32 v182, v182, v183
    v_add_f32_e64 v180, v180, v182
    s_waitcnt vmcnt(6)
    v_mfma_f32_16x16x32_bf16 v[160:163], v[8:11], v[116:119], v[160:163]
    v_mfma_f32_16x16x32_bf16 v[164:167], v[10:13], v[116:119], v[164:167]
    v_add_f32 v184, v184, v185
    v_add_f32_e64 v186, v186, v187
    s_waitcnt vmcnt(5)
    v_mfma_f32_16x16x32_bf16 v[160:163], v[8:11], v[120:123], v[160:163]
    v_mfma_f32_16x16x32_bf16 v[164:167], v[10:13], v[120:123], v[164:167]
    v_add_f32 v184, v184, v186
    v_add_f32_e64 v188, v188, v189
    s_waitcnt vmcnt(4)
    v_mfma_f32_16x16x32_bf16 v[160:163], v[8:11], v[124:127], v[160:163]
    v_mfma_f32_16x16x32_bf16 v[164:167], v[10:13], v[124:127], v[164:167]
    v_add_f32 v190, v190, v191
    v_add_f32_e64 v188, v188, v190
    s_waitcnt vmcnt(3)
    v_mfma_f32_16x16x32_bf16 v[160:163], v[8:11], v[128:131], v[160:163]
    v_mfma_f32_16x16x32_bf16 v[164:167], v[10:13], v[128:131], v[164:167]
    v_permlane32_swap_b32 v176, v184
    v_permlane32_swap_b32 v180, v188
    s_waitcnt vmcnt(2)
    v_mfma_f32_16x16x32_bf16 v[160:163], v[8:11], v[132:135], v[160:163]
    v_mfma_f32_16x16x32_bf16 v[164:167], v[10:13], v[132:135], v[164:167]
    v_add_f32 v176, v176, v184
    v_add_f32 v180, v180, v188
    s_waitcnt vmcnt(1)
    v_mfma_f32_16x16x32_bf16 v[160:163], v[8:11], v[136:139], v[160:163]
    v_mfma_f32_16x16x32_bf16 v[164:167], v[10:13], v[136:139], v[164:167]
    v_permlane16_swap_b32 v176, v180
    v_add_f32_e64 v176, v176, v180
    s_waitcnt vmcnt(0)
    v_mfma_f32_16x16x32_bf16 v[160:163], v[8:11], v[140:143], v[160:163]
    v_mfma_f32_16x16x32_bf16 v[164:167], v[10:13], v[140:143], v[164:167]
    v_add_f32 v176, s72, v176
    v_rcp_f32 v176, v176
    s_nop 0
    v_mov_b32 v180, v176
    s_nop 1
    v_permlane16_swap_b32 v176, v180
    v_mov_b32 v184, v176
    v_mov_b32_e64 v188, v180
    s_nop 0
    v_permlane32_swap_b32 v176, v184
    v_permlane32_swap_b32 v180, v188
    v_cvt_pk_bf16_f32 v112, v160, v161
    v_cvt_pk_bf16_f32 v113, v162, v163
    v_cvt_pk_bf16_f32 v114, v164, v165
    v_cvt_pk_bf16_f32 v115, v166, v167
    ds_write_b128 v206, v[112:115]
    ds_write_b32 v4, v6 offset:16
    s_mov_b32 s69, 3200000
fpoll_12:
    ds_read_b32 v14, v5
    ds_read_b128 v[116:119], v3
    ds_read_b128 v[120:123], v3 offset:1024
    s_waitcnt lgkmcnt(0)
    v_cmp_ne_u32 vcc, 0, v14
    s_cbranch_vccnz fpolld_13
    s_sub_u32 s69, s69, 1
    s_cmp_lg_u32 s69, 0
    s_cbranch_scc1 fpoll_12
fpolld_13:
    v_mfma_f32_16x16x32_bf16 v[16:19], v[116:119], v[48:51], 0
    v_mfma_f32_16x16x32_bf16 v[20:23], v[120:123], v[48:51], 0
    v_mfma_f32_16x16x32_bf16 v[24:27], v[116:119], v[52:55], 0
    v_mfma_f32_16x16x32_bf16 v[28:31], v[120:123], v[52:55], 0
    v_mfma_f32_16x16x32_bf16 v[32:35], v[116:119], v[56:59], 0
    v_mfma_f32_16x16x32_bf16 v[36:39], v[120:123], v[56:59], 0
    v_mfma_f32_16x16x32_bf16 v[40:43], v[116:119], v[60:63], 0
    v_mfma_f32_16x16x32_bf16 v[44:47], v[120:123], v[60:63], 0
    s_nop 0
    v_mul_f32 v16, v16, v176
    v_mul_f32_e64 v17, v17, v176
    v_cvt_pk_bf16_f32 v124, v16, v17
    v_mul_f32 v18, v18, v176
    v_mul_f32 v19, v19, v176
    v_cvt_pk_bf16_f32 v125, v18, v19
    v_mul_f32 v20, v20, v176
    v_mul_f32 v21, v21, v176
    v_cvt_pk_bf16_f32 v126, v20, v21
    v_mul_f32 v22, v22, v176
    v_mul_f32 v23, v23, v176
    v_cvt_pk_bf16_f32 v127, v22, v23
    buffer_store_dwordx4 v[124:127], v15, s[52:55], s80 offen sc1
    s_add_u32 s80, s80, 32768
    v_mul_f32 v24, v24, v180
    v_mul_f32 v25, v25, v180
    v_cvt_pk_bf16_f32 v128, v24, v25
    v_mul_f32 v26, v26, v180
    v_mul_f32 v27, v27, v180
    v_cvt_pk_bf16_f32 v129, v26, v27
    v_mul_f32 v28, v28, v180
    v_mul_f32 v29, v29, v180
    v_cvt_pk_bf16_f32 v130, v28, v29
    v_mul_f32 v30, v30, v180
    v_mul_f32 v31, v31, v180
    v_cvt_pk_bf16_f32 v131, v30, v31
    buffer_store_dwordx4 v[128:131], v15, s[52:55], s80 offen sc1
    s_add_u32 s80, s80, 32768
    v_mul_f32 v32, v32, v184
    v_mul_f32 v33, v33, v184
    v_cvt_pk_bf16_f32 v132, v32, v33
    v_mul_f32 v34, v34, v184
    v_mul_f32 v35, v35, v184
    v_cvt_pk_bf16_f32 v133, v34, v35
    v_mul_f32 v36, v36, v184
    v_mul_f32 v37, v37, v184
    v_cvt_pk_bf16_f32 v134, v36, v37
    v_mul_f32 v38, v38, v184
    v_mul_f32 v39, v39, v184
    v_cvt_pk_bf16_f32 v135, v38, v39
    buffer_store_dwordx4 v[132:135], v15, s[52:55], s80 offen sc1
    s_add_u32 s80, s80, 32768
    v_mul_f32 v40, v40, v188
    v_mul_f32 v41, v41, v188
    v_cvt_pk_bf16_f32 v136, v40, v41
    v_mul_f32 v42, v42, v188
    v_mul_f32 v43, v43, v188
    v_cvt_pk_bf16_f32 v137, v42, v43
    v_mul_f32 v44, v44, v188
    v_mul_f32 v45, v45, v188
    v_cvt_pk_bf16_f32 v138, v44, v45
    v_mul_f32 v46, v46, v188
    v_mul_f32 v47, v47, v188
    v_cvt_pk_bf16_f32 v139, v46, v47
    buffer_store_dwordx4 v[136:139], v15, s[52:55], s80 offen sc1
    s_add_u32 s80, s80, 32768
    ds_write_b32 v4, v6 offset:112
    v_lshrrev_b32 v7, 2, v0
    v_lshlrev_b32 v7, 7, v7
    v_lshl_add_u32 v7, v1, 1, v7
    v_bfe_u32 v8, v0, 3, 2
    v_lshl_add_u32 v192, v8, 5, v7
    v_xor_b32 v193, 32, v192
    v_xor_b32 v194, 64, v192
    v_xor_b32 v195, 96, v192
    v_add_u32 v196, 65536, v192
    v_add_u32 v197, 65536, v193
    v_add_u32 v198, 65536, v194
    v_add_u32 v199, 65536, v195
    v_add_u32 v200, 131072, v192
    v_add_u32 v201, 131072, v193
    v_add_u32 v202, 131072, v194
    v_add_u32 v203, 131072, v195
    s_lshl_b32 s78, s34, 2
    s_add_u32 s78, s78, s66
    s_lshl_b32 s79, s78, 16
    s_add_u32 s79, s79, 4194304
    s_lshl_b32 s80, s100, 11
    v_add_u32 v12, 32768, v15
    s_waitcnt vmcnt(0)
    v_mov_b32 v10, 72
    v_mov_b32_e64 v14, 1
    s_mov_b64 exec, 1
    ds_add_rtn_u32 v14, v10, v14
    s_mov_b64 exec, -1
    s_lshl_b32 s68, s63, 11
    s_add_u32 s68, s68, 32768
    s_lshl_b32 s69, s62, 7
    s_add_u32 s68, s68, s69
    s_waitcnt lgkmcnt(0)
    v_readfirstlane_b32 s77, v14
    s_mov_b32 s3, 1
    s_nop 1
    s_cmp_eq_u32 s77, 3
    s_cbranch_scc0 notlast_14
    s_atomic_add s3, s[32:33], s68
notlast_14:
    v_and_b32 v2, 7, v0
    v_lshlrev_b32 v2, 12, v2
    v_bfe_u32 v3, v0, 3, 1
    v_lshl_add_u32 v2, v3, 6, v2
    v_bfe_u32 v3, v0, 4, 1
    v_lshl_add_u32 v2, v3, 5, v2
    v_lshrrev_b32_e64 v3, 5, v0
    v_lshl_add_u32 v2, v3, 4, v2
    s_lshl_b32 s74, s78, 17
    s_lshl_b32 s69, s35, 7
    s_add_u32 s74, s74, s69
    s_add_u32 s75, s74, 65536
    s_add_u32 s4, s80, s79
    s_add_u32 s80, s80, 2048
    s_and_b32 s80, s80, 0x7fff
    s_add_u32 s5, s80, s79
    s_add_u32 s80, s80, 2048
    s_and_b32 s80, s80, 0x7fff
    s_add_u32 s6, s80, s79
    s_add_u32 s80, s80, 2048
    s_and_b32 s80, s80, 0x7fff
    s_add_u32 s7, s80, s79
    s_add_u32 s80, s80, 2048
    s_and_b32 s80, s80, 0x7fff
    s_add_u32 s8, s80, s79
    s_add_u32 s80, s80, 2048
    s_and_b32 s80, s80, 0x7fff
    s_add_u32 s9, s80, s79
    s_add_u32 s80, s80, 2048
    s_and_b32 s80, s80, 0x7fff
    s_add_u32 s10, s80, s79
    s_add_u32 s80, s80, 2048
    s_and_b32 s80, s80, 0x7fff
    s_add_u32 s11, s80, s79
    s_add_u32 s80, s80, 2048
    s_and_b32 s80, s80, 0x7fff
    s_add_u32 s12, s80, s79
    s_add_u32 s80, s80, 2048
    s_and_b32 s80, s80, 0x7fff
    s_add_u32 s13, s80, s79
    s_add_u32 s80, s80, 2048
    s_and_b32 s80, s80, 0x7fff
    s_add_u32 s14, s80, s79
    s_add_u32 s80, s80, 2048
    s_and_b32 s80, s80, 0x7fff
    s_add_u32 s15, s80, s79
    s_add_u32 s80, s80, 2048
    s_and_b32 s80, s80, 0x7fff
    s_add_u32 s16, s80, s79
    s_add_u32 s80, s80, 2048
    s_and_b32 s80, s80, 0x7fff
    s_add_u32 s17, s80, s79
    s_add_u32 s80, s80, 2048
    s_and_b32 s80, s80, 0x7fff
    s_add_u32 s18, s80, s79
    s_add_u32 s80, s80, 2048
    s_and_b32 s80, s80, 0x7fff
    s_add_u32 s19, s80, s79
    s_add_u32 s80, s80, 2048
    s_and_b32 s80, s80, 0x7fff
    s_cmp_eq_u32 s77, 3
    s_cbranch_scc0 follow_15
    s_mov_b64 exec, 0xffff
    s_lshl_b32 s68, s34, 11
    s_add_u32 s68, s68, 32768
    v_lshlrev_b32_e64 v10, 7, v0
    s_mov_b32 s22, 400000
    s_waitcnt lgkmcnt(0)
gp_16:
    buffer_load_dword v14, v10, s[52:55], s68 offen sc1
    s_waitcnt vmcnt(0)
    v_cmp_eq_u32_e64 vcc, 0, v14
    s_cbranch_vccz gpd_17
    s_sub_u32 s22, s22, 1
    s_cmp_lg_u32 s22, 0
    s_cbranch_scc1 gp_16
gpd_17:
    v_mov_b32 v10, 76
    v_mov_b32_e64 v14, 1
    ds_write_b32 v10, v14
    s_mov_b64 exec, -1
    s_branch gpe_18
follow_15:
    v_mov_b32 v10, 76
    s_mov_b32 s69, 3200000
lpoll_19:
    ds_read_b32 v14, v10 offset:0
    s_waitcnt lgkmcnt(0)
    v_cmp_ne_u32 vcc, 0, v14
    s_cmp_eq_u64 vcc, -1
    s_cbranch_scc1 lpolld_20
    s_sleep 1
    s_sub_u32 s69, s69, 1
    s_cmp_lg_u32 s69, 0
    s_cbranch_scc1 lpoll_19
lpolld_20:
gpe_18:
    buffer_load_dwordx4 v[112:115], v15, s[52:55], s4 offen offset:0 sc1
    buffer_load_dwordx4 v[116:119], v12, s[52:55], s4 offen offset:0 sc1
    buffer_load_dwordx4 v[120:123], v15, s[52:55], s4 offen offset:1024 sc1
    buffer_load_dwordx4 v[124:127], v12, s[52:55], s4 offen offset:1024 sc1
    buffer_load_dwordx4 v[128:131], v15, s[52:55], s5 offen offset:0 sc1
    buffer_load_dwordx4 v[132:135], v12, s[52:55], s5 offen offset:0 sc1
    buffer_load_dwordx4 v[136:139], v15, s[52:55], s5 offen offset:1024 sc1
    buffer_load_dwordx4 v[140:143], v12, s[52:55], s5 offen offset:1024 sc1
    s_mov_b32 s69, 3200000
lpoll_21:
    ds_read_b32 v14, v1 offset:32
    s_waitcnt lgkmcnt(0)
    v_cmp_ne_u32_e64 vcc, 0, v14
    s_cmp_eq_u64 vcc, -1
    s_cbranch_scc1 lpolld_22
    s_sleep 1
    s_sub_u32 s69, s69, 1
    s_cmp_lg_u32 s69, 0
    s_cbranch_scc1 lpoll_21
lpolld_22:
    s_setprio 0
    ds_read_b64_tr_b16 v[80:81], v192 offset:20480
    ds_read_b64_tr_b16 v[82:83], v192 offset:22528
    ds_read_b64_tr_b16 v[84:85], v193 offset:20480
    ds_read_b64_tr_b16 v[86:87], v193 offset:22528
    ds_read_b64_tr_b16 v[88:89], v194 offset:20480
    ds_read_b64_tr_b16 v[90:91], v194 offset:22528
    ds_read_b64_tr_b16 v[92:93], v195 offset:20480
    ds_read_b64_tr_b16 v[94:95], v195 offset:22528
    s_waitcnt vmcnt(6) lgkmcnt(4)
    .p2align 3
    v_mfma_f32_16x16x32_bf16 v[16:19], v[80:83], v[112:115], 0
    ds_read_b64_tr_b16 v[96:97], v192 offset:24576
    ds_read_b64_tr_b16 v[98:99], v192 offset:26624
    v_mfma_f32_16x16x32_bf16 v[32:35], v[80:83], v[116:119], 0
    ds_read_b64_tr_b16 v[100:101], v193 offset:24576
    ds_read_b64_tr_b16 v[102:103], v193 offset:26624
    v_mfma_f32_16x16x32_bf16 v[36:39], v[84:87], v[116:119], 0
    buffer_load_dwordx4 v[144:147], v15, s[52:55], s6 offen offset:0 sc1
    v_mfma_f32_16x16x32_bf16 v[20:23], v[84:87], v[112:115], 0
    s_waitcnt lgkmcnt(4)
    s_nop 0
    v_mfma_f32_16x16x32_bf16 v[24:27], v[88:91], v[112:115], 0
    ds_read_b64_tr_b16 v[104:105], v194 offset:24576
    ds_read_b64_tr_b16 v[106:107], v194 offset:26624
    v_mfma_f32_16x16x32_bf16 v[40:43], v[88:91], v[116:119], 0
    ds_read_b64_tr_b16 v[108:109], v195 offset:24576
    ds_read_b64_tr_b16 v[110:111], v195 offset:26624
    v_mfma_f32_16x16x32_bf16 v[44:47], v[92:95], v[116:119], 0
    buffer_load_dwordx4 v[148:151], v12, s[52:55], s6 offen offset:0 sc1
    v_mfma_f32_16x16x32_bf16 v[28:31], v[92:95], v[112:115], 0
    s_waitcnt vmcnt(6) lgkmcnt(4)
    s_nop 0
    v_mfma_f32_16x16x32_bf16 v[16:19], v[96:99], v[120:123], v[16:19]
    ds_read_b64_tr_b16 v[80:81], v192 offset:28672
    ds_read_b64_tr_b16 v[82:83], v192 offset:30720
    v_mfma_f32_16x16x32_bf16 v[32:35], v[96:99], v[124:127], v[32:35]
    ds_read_b64_tr_b16 v[84:85], v193 offset:28672
    ds_read_b64_tr_b16 v[86:87], v193 offset:30720
    v_mfma_f32_16x16x32_bf16 v[36:39], v[100:103], v[124:127], v[36:39]
    buffer_load_dwordx4 v[112:115], v15, s[52:55], s6 offen offset:1024 sc1
    v_mfma_f32_16x16x32_bf16 v[20:23], v[100:103], v[120:123], v[20:23]
    s_waitcnt lgkmcnt(4)
    s_nop 0
    v_mfma_f32_16x16x32_bf16 v[24:27], v[104:107], v[120:123], v[24:27]
    ds_read_b64_tr_b16 v[88:89], v194 offset:28672
    ds_read_b64_tr_b16 v[90:91], v194 offset:30720
    v_mfma_f32_16x16x32_bf16 v[40:43], v[104:107], v[124:127], v[40:43]
    ds_read_b64_tr_b16 v[92:93], v195 offset:28672
    ds_read_b64_tr_b16 v[94:95], v195 offset:30720
    v_mfma_f32_16x16x32_bf16 v[44:47], v[108:111], v[124:127], v[44:47]
    buffer_load_dwordx4 v[116:119], v12, s[52:55], s6 offen offset:1024 sc1
    v_mfma_f32_16x16x32_bf16 v[28:31], v[108:111], v[120:123], v[28:31]
    s_waitcnt vmcnt(6) lgkmcnt(4)
    s_nop 0
    v_mfma_f32_16x16x32_bf16 v[16:19], v[80:83], v[128:131], v[16:19]
    ds_read_b64_tr_b16 v[96:97], v192 offset:32768
    ds_read_b64_tr_b16 v[98:99], v192 offset:34816
    v_mfma_f32_16x16x32_bf16 v[32:35], v[80:83], v[132:135], v[32:35]
    ds_read_b64_tr_b16 v[100:101], v193 offset:32768
    ds_read_b64_tr_b16 v[102:103], v193 offset:34816
    v_mfma_f32_16x16x32_bf16 v[36:39], v[84:87], v[132:135], v[36:39]
    buffer_load_dwordx4 v[120:123], v15, s[52:55], s7 offen offset:0 sc1
    v_mfma_f32_16x16x32_bf16 v[20:23], v[84:87], v[128:131], v[20:23]
    s_waitcnt lgkmcnt(4)
    s_nop 0
    v_mfma_f32_16x16x32_bf16 v[24:27], v[88:91], v[128:131], v[24:27]
    ds_read_b64_tr_b16 v[104:105], v194 offset:32768
    ds_read_b64_tr_b16 v[106:107], v194 offset:34816
    v_mfma_f32_16x16x32_bf16 v[40:43], v[88:91], v[132:135], v[40:43]
    ds_read_b64_tr_b16 v[108:109], v195 offset:32768
    ds_read_b64_tr_b16 v[110:111], v195 offset:34816
    v_mfma_f32_16x16x32_bf16 v[44:47], v[92:95], v[132:135], v[44:47]
    buffer_load_dwordx4 v[124:127], v12, s[52:55], s7 offen offset:0 sc1
    v_mfma_f32_16x16x32_bf16 v[28:31], v[92:95], v[128:131], v[28:31]
    s_waitcnt vmcnt(6) lgkmcnt(4)
    s_nop 0
    v_mfma_f32_16x16x32_bf16 v[16:19], v[96:99], v[136:139], v[16:19]
    ds_read_b64_tr_b16 v[80:81], v196 offset:40960
    ds_read_b64_tr_b16 v[82:83], v196 offset:43008
    v_mfma_f32_16x16x32_bf16 v[32:35], v[96:99], v[140:143], v[32:35]
    ds_read_b64_tr_b16 v[84:85], v197 offset:40960
    ds_read_b64_tr_b16 v[86:87], v197 offset:43008
    v_mfma_f32_16x16x32_bf16 v[36:39], v[100:103], v[140:143], v[36:39]
    buffer_load_dwordx4 v[128:131], v15, s[52:55], s7 offen offset:1024 sc1
    v_mfma_f32_16x16x32_bf16 v[20:23], v[100:103], v[136:139], v[20:23]
    s_waitcnt lgkmcnt(4)
    s_nop 0
    v_mfma_f32_16x16x32_bf16 v[24:27], v[104:107], v[136:139], v[24:27]
    ds_read_b64_tr_b16 v[88:89], v198 offset:40960
    ds_read_b64_tr_b16 v[90:91], v198 offset:43008
    v_mfma_f32_16x16x32_bf16 v[40:43], v[104:107], v[140:143], v[40:43]
    ds_read_b64_tr_b16 v[92:93], v199 offset:40960
    ds_read_b64_tr_b16 v[94:95], v199 offset:43008
    v_mfma_f32_16x16x32_bf16 v[44:47], v[108:111], v[140:143], v[44:47]
    buffer_load_dwordx4 v[132:135], v12, s[52:55], s7 offen offset:1024 sc1
    v_mfma_f32_16x16x32_bf16 v[28:31], v[108:111], v[136:139], v[28:31]
    s_waitcnt vmcnt(6) lgkmcnt(4)
    s_nop 0
    v_mfma_f32_16x16x32_bf16 v[16:19], v[80:83], v[144:147], v[16:19]
    ds_read_b64_tr_b16 v[96:97], v196 offset:45056
    ds_read_b64_tr_b16 v[98:99], v196 offset:47104
    v_mfma_f32_16x16x32_bf16 v[32:35], v[80:83], v[148:151], v[32:35]
    ds_read_b64_tr_b16 v[100:101], v197 offset:45056
    ds_read_b64_tr_b16 v[102:103], v197 offset:47104
    v_mfma_f32_16x16x32_bf16 v[36:39], v[84:87], v[148:151], v[36:39]
    buffer_load_dwordx4 v[136:139], v15, s[52:55], s8 offen offset:0 sc1
    v_mfma_f32_16x16x32_bf16 v[20:23], v[84:87], v[144:147], v[20:23]
    s_waitcnt lgkmcnt(4)
    s_nop 0
    v_mfma_f32_16x16x32_bf16 v[24:27], v[88:91], v[144:147], v[24:27]
    ds_read_b64_tr_b16 v[104:105], v198 offset:45056
    ds_read_b64_tr_b16 v[106:107], v198 offset:47104
    v_mfma_f32_16x16x32_bf16 v[40:43], v[88:91], v[148:151], v[40:43]
    ds_read_b64_tr_b16 v[108:109], v199 offset:45056
    ds_read_b64_tr_b16 v[110:111], v199 offset:47104
    v_mfma_f32_16x16x32_bf16 v[44:47], v[92:95], v[148:151], v[44:47]
    buffer_load_dwordx4 v[140:143], v12, s[52:55], s8 offen offset:0 sc1
    v_mfma_f32_16x16x32_bf16 v[28:31], v[92:95], v[144:147], v[28:31]
    s_waitcnt vmcnt(6) lgkmcnt(4)
    s_nop 0
    v_mfma_f32_16x16x32_bf16 v[16:19], v[96:99], v[112:115], v[16:19]
    ds_read_b64_tr_b16 v[80:81], v196 offset:49152
    ds_read_b64_tr_b16 v[82:83], v196 offset:51200
    v_mfma_f32_16x16x32_bf16 v[32:35], v[96:99], v[116:119], v[32:35]
    ds_read_b64_tr_b16 v[84:85], v197 offset:49152
    ds_read_b64_tr_b16 v[86:87], v197 offset:51200
    v_mfma_f32_16x16x32_bf16 v[36:39], v[100:103], v[116:119], v[36:39]
    buffer_load_dwordx4 v[144:147], v15, s[52:55], s8 offen offset:1024 sc1
    v_mfma_f32_16x16x32_bf16 v[20:23], v[100:103], v[112:115], v[20:23]
    s_waitcnt lgkmcnt(4)
    s_nop 0
    v_mfma_f32_16x16x32_bf16 v[24:27], v[104:107], v[112:115], v[24:27]
    ds_read_b64_tr_b16 v[88:89], v198 offset:49152
    ds_read_b64_tr_b16 v[90:91], v198 offset:51200
    v_mfma_f32_16x16x32_bf16 v[40:43], v[104:107], v[116:119], v[40:43]
    ds_read_b64_tr_b16 v[92:93], v199 offset:49152
    ds_read_b64_tr_b16 v[94:95], v199 offset:51200
    v_mfma_f32_16x16x32_bf16 v[44:47], v[108:111], v[116:119], v[44:47]
    buffer_load_dwordx4 v[148:151], v12, s[52:55], s8 offen offset:1024 sc1
    v_mfma_f32_16x16x32_bf16 v[28:31], v[108:111], v[112:115], v[28:31]
    s_waitcnt vmcnt(6) lgkmcnt(4)
    s_nop 0
    v_mfma_f32_16x16x32_bf16 v[16:19], v[80:83], v[120:123], v[16:19]
    ds_read_b64_tr_b16 v[96:97], v196 offset:53248
    ds_read_b64_tr_b16 v[98:99], v196 offset:55296
    v_mfma_f32_16x16x32_bf16 v[32:35], v[80:83], v[124:127], v[32:35]
    ds_read_b64_tr_b16 v[100:101], v197 offset:53248
    ds_read_b64_tr_b16 v[102:103], v197 offset:55296
    v_mfma_f32_16x16x32_bf16 v[36:39], v[84:87], v[124:127], v[36:39]
    buffer_load_dwordx4 v[112:115], v15, s[52:55], s9 offen offset:0 sc1
    v_mfma_f32_16x16x32_bf16 v[20:23], v[84:87], v[120:123], v[20:23]
    s_waitcnt lgkmcnt(4)
    s_nop 0
    v_mfma_f32_16x16x32_bf16 v[24:27], v[88:91], v[120:123], v[24:27]
    ds_read_b64_tr_b16 v[104:105], v198 offset:53248
    ds_read_b64_tr_b16 v[106:107], v198 offset:55296
    v_mfma_f32_16x16x32_bf16 v[40:43], v[88:91], v[124:127], v[40:43]
    ds_read_b64_tr_b16 v[108:109], v199 offset:53248
    ds_read_b64_tr_b16 v[110:111], v199 offset:55296
    v_mfma_f32_16x16x32_bf16 v[44:47], v[92:95], v[124:127], v[44:47]
    buffer_load_dwordx4 v[116:119], v12, s[52:55], s9 offen offset:0 sc1
    v_mfma_f32_16x16x32_bf16 v[28:31], v[92:95], v[120:123], v[28:31]
    s_waitcnt vmcnt(6) lgkmcnt(4)
    s_nop 0
    v_mfma_f32_16x16x32_bf16 v[16:19], v[96:99], v[128:131], v[16:19]
    ds_read_b64_tr_b16 v[80:81], v196 offset:57344
    ds_read_b64_tr_b16 v[82:83], v196 offset:59392
    v_mfma_f32_16x16x32_bf16 v[32:35], v[96:99], v[132:135], v[32:35]
    ds_read_b64_tr_b16 v[84:85], v197 offset:57344
    ds_read_b64_tr_b16 v[86:87], v197 offset:59392
    v_mfma_f32_16x16x32_bf16 v[36:39], v[100:103], v[132:135], v[36:39]
    buffer_load_dwordx4 v[120:123], v15, s[52:55], s9 offen offset:1024 sc1
    v_mfma_f32_16x16x32_bf16 v[20:23], v[100:103], v[128:131], v[20:23]
    s_waitcnt lgkmcnt(4)
    s_nop 0
    v_mfma_f32_16x16x32_bf16 v[24:27], v[104:107], v[128:131], v[24:27]
    ds_read_b64_tr_b16 v[88:89], v198 offset:57344
    ds_read_b64_tr_b16 v[90:91], v198 offset:59392
    v_mfma_f32_16x16x32_bf16 v[40:43], v[104:107], v[132:135], v[40:43]
    ds_read_b64_tr_b16 v[92:93], v199 offset:57344
    ds_read_b64_tr_b16 v[94:95], v199 offset:59392
    v_mfma_f32_16x16x32_bf16 v[44:47], v[108:111], v[132:135], v[44:47]
    buffer_load_dwordx4 v[124:127], v12, s[52:55], s9 offen offset:1024 sc1
    v_mfma_f32_16x16x32_bf16 v[28:31], v[108:111], v[128:131], v[28:31]
    s_waitcnt vmcnt(6) lgkmcnt(4)
    s_nop 0
    v_mfma_f32_16x16x32_bf16 v[16:19], v[80:83], v[136:139], v[16:19]
    ds_read_b64_tr_b16 v[96:97], v196 offset:61440
    ds_read_b64_tr_b16 v[98:99], v196 offset:63488
    v_mfma_f32_16x16x32_bf16 v[32:35], v[80:83], v[140:143], v[32:35]
    ds_read_b64_tr_b16 v[100:101], v197 offset:61440
    ds_read_b64_tr_b16 v[102:103], v197 offset:63488
    v_mfma_f32_16x16x32_bf16 v[36:39], v[84:87], v[140:143], v[36:39]
    buffer_load_dwordx4 v[128:131], v15, s[52:55], s10 offen offset:0 sc1
    v_mfma_f32_16x16x32_bf16 v[20:23], v[84:87], v[136:139], v[20:23]
    s_waitcnt lgkmcnt(4)
    s_nop 0
    v_mfma_f32_16x16x32_bf16 v[24:27], v[88:91], v[136:139], v[24:27]
    ds_read_b64_tr_b16 v[104:105], v198 offset:61440
    ds_read_b64_tr_b16 v[106:107], v198 offset:63488
    v_mfma_f32_16x16x32_bf16 v[40:43], v[88:91], v[140:143], v[40:43]
    ds_read_b64_tr_b16 v[108:109], v199 offset:61440
    ds_read_b64_tr_b16 v[110:111], v199 offset:63488
    v_mfma_f32_16x16x32_bf16 v[44:47], v[92:95], v[140:143], v[44:47]
    buffer_load_dwordx4 v[132:135], v12, s[52:55], s10 offen offset:0 sc1
    v_mfma_f32_16x16x32_bf16 v[28:31], v[92:95], v[136:139], v[28:31]
    s_waitcnt vmcnt(6) lgkmcnt(4)
    s_nop 0
    v_mfma_f32_16x16x32_bf16 v[16:19], v[96:99], v[144:147], v[16:19]
    ds_read_b64_tr_b16 v[80:81], v200 offset:0
    ds_read_b64_tr_b16 v[82:83], v200 offset:2048
    v_mfma_f32_16x16x32_bf16 v[32:35], v[96:99], v[148:151], v[32:35]
    ds_read_b64_tr_b16 v[84:85], v201 offset:0
    ds_read_b64_tr_b16 v[86:87], v201 offset:2048
    v_mfma_f32_16x16x32_bf16 v[36:39], v[100:103], v[148:151], v[36:39]
    buffer_load_dwordx4 v[136:139], v15, s[52:55], s10 offen offset:1024 sc1
    v_mfma_f32_16x16x32_bf16 v[20:23], v[100:103], v[144:147], v[20:23]
    s_waitcnt lgkmcnt(4)
    s_nop 0
    v_mfma_f32_16x16x32_bf16 v[24:27], v[104:107], v[144:147], v[24:27]
    ds_read_b64_tr_b16 v[88:89], v202 offset:0
    ds_read_b64_tr_b16 v[90:91], v202 offset:2048
    v_mfma_f32_16x16x32_bf16 v[40:43], v[104:107], v[148:151], v[40:43]
    ds_read_b64_tr_b16 v[92:93], v203 offset:0
    ds_read_b64_tr_b16 v[94:95], v203 offset:2048
    v_mfma_f32_16x16x32_bf16 v[44:47], v[108:111], v[148:151], v[44:47]
    buffer_load_dwordx4 v[140:143], v12, s[52:55], s10 offen offset:1024 sc1
    v_mfma_f32_16x16x32_bf16 v[28:31], v[108:111], v[144:147], v[28:31]
    s_waitcnt vmcnt(6) lgkmcnt(4)
    s_nop 0
    v_mfma_f32_16x16x32_bf16 v[16:19], v[80:83], v[112:115], v[16:19]
    ds_read_b64_tr_b16 v[96:97], v200 offset:4096
    ds_read_b64_tr_b16 v[98:99], v200 offset:6144
    v_mfma_f32_16x16x32_bf16 v[32:35], v[80:83], v[116:119], v[32:35]
    ds_read_b64_tr_b16 v[100:101], v201 offset:4096
    ds_read_b64_tr_b16 v[102:103], v201 offset:6144
    v_mfma_f32_16x16x32_bf16 v[36:39], v[84:87], v[116:119], v[36:39]
    buffer_load_dwordx4 v[144:147], v15, s[52:55], s11 offen offset:0 sc1
    v_mfma_f32_16x16x32_bf16 v[20:23], v[84:87], v[112:115], v[20:23]
    s_waitcnt lgkmcnt(4)
    s_nop 0
    v_mfma_f32_16x16x32_bf16 v[24:27], v[88:91], v[112:115], v[24:27]
    ds_read_b64_tr_b16 v[104:105], v202 offset:4096
    ds_read_b64_tr_b16 v[106:107], v202 offset:6144
    v_mfma_f32_16x16x32_bf16 v[40:43], v[88:91], v[116:119], v[40:43]
    ds_read_b64_tr_b16 v[108:109], v203 offset:4096
    ds_read_b64_tr_b16 v[110:111], v203 offset:6144
    v_mfma_f32_16x16x32_bf16 v[44:47], v[92:95], v[116:119], v[44:47]
    buffer_load_dwordx4 v[148:151], v12, s[52:55], s11 offen offset:0 sc1
    v_mfma_f32_16x16x32_bf16 v[28:31], v[92:95], v[112:115], v[28:31]
    s_waitcnt vmcnt(6) lgkmcnt(4)
    s_nop 0
    v_mfma_f32_16x16x32_bf16 v[16:19], v[96:99], v[120:123], v[16:19]
    ds_read_b64_tr_b16 v[80:81], v200 offset:8192
    ds_read_b64_tr_b16 v[82:83], v200 offset:10240
    v_mfma_f32_16x16x32_bf16 v[32:35], v[96:99], v[124:127], v[32:35]
    ds_read_b64_tr_b16 v[84:85], v201 offset:8192
    ds_read_b64_tr_b16 v[86:87], v201 offset:10240
    v_mfma_f32_16x16x32_bf16 v[36:39], v[100:103], v[124:127], v[36:39]
    buffer_load_dwordx4 v[112:115], v15, s[52:55], s11 offen offset:1024 sc1
    v_mfma_f32_16x16x32_bf16 v[20:23], v[100:103], v[120:123], v[20:23]
    s_waitcnt lgkmcnt(4)
    s_nop 0
    v_mfma_f32_16x16x32_bf16 v[24:27], v[104:107], v[120:123], v[24:27]
    ds_read_b64_tr_b16 v[88:89], v202 offset:8192
    ds_read_b64_tr_b16 v[90:91], v202 offset:10240
    v_mfma_f32_16x16x32_bf16 v[40:43], v[104:107], v[124:127], v[40:43]
    ds_read_b64_tr_b16 v[92:93], v203 offset:8192
    ds_read_b64_tr_b16 v[94:95], v203 offset:10240
    v_mfma_f32_16x16x32_bf16 v[44:47], v[108:111], v[124:127], v[44:47]
    buffer_load_dwordx4 v[116:119], v12, s[52:55], s11 offen offset:1024 sc1
    v_mfma_f32_16x16x32_bf16 v[28:31], v[108:111], v[120:123], v[28:31]
    s_waitcnt vmcnt(6) lgkmcnt(4)
    s_nop 0
    v_mfma_f32_16x16x32_bf16 v[16:19], v[80:83], v[128:131], v[16:19]
    ds_read_b64_tr_b16 v[96:97], v200 offset:12288
    ds_read_b64_tr_b16 v[98:99], v200 offset:14336
    v_mfma_f32_16x16x32_bf16 v[32:35], v[80:83], v[132:135], v[32:35]
    ds_read_b64_tr_b16 v[100:101], v201 offset:12288
    ds_read_b64_tr_b16 v[102:103], v201 offset:14336
    v_mfma_f32_16x16x32_bf16 v[36:39], v[84:87], v[132:135], v[36:39]
    buffer_load_dwordx4 v[120:123], v15, s[52:55], s12 offen offset:0 sc1
    v_mfma_f32_16x16x32_bf16 v[20:23], v[84:87], v[128:131], v[20:23]
    s_waitcnt lgkmcnt(4)
    s_nop 0
    v_mfma_f32_16x16x32_bf16 v[24:27], v[88:91], v[128:131], v[24:27]
    ds_read_b64_tr_b16 v[104:105], v202 offset:12288
    ds_read_b64_tr_b16 v[106:107], v202 offset:14336
    v_mfma_f32_16x16x32_bf16 v[40:43], v[88:91], v[132:135], v[40:43]
    ds_read_b64_tr_b16 v[108:109], v203 offset:12288
    ds_read_b64_tr_b16 v[110:111], v203 offset:14336
    v_mfma_f32_16x16x32_bf16 v[44:47], v[92:95], v[132:135], v[44:47]
    buffer_load_dwordx4 v[124:127], v12, s[52:55], s12 offen offset:0 sc1
    v_mfma_f32_16x16x32_bf16 v[28:31], v[92:95], v[128:131], v[28:31]
    s_waitcnt vmcnt(6) lgkmcnt(4)
    s_nop 0
    v_mfma_f32_16x16x32_bf16 v[16:19], v[96:99], v[136:139], v[16:19]
    ds_read_b64_tr_b16 v[80:81], v200 offset:16384
    ds_read_b64_tr_b16 v[82:83], v200 offset:18432
    v_mfma_f32_16x16x32_bf16 v[32:35], v[96:99], v[140:143], v[32:35]
    ds_read_b64_tr_b16 v[84:85], v201 offset:16384
    ds_read_b64_tr_b16 v[86:87], v201 offset:18432
    v_mfma_f32_16x16x32_bf16 v[36:39], v[100:103], v[140:143], v[36:39]
    buffer_load_dwordx4 v[128:131], v15, s[52:55], s12 offen offset:1024 sc1
    v_mfma_f32_16x16x32_bf16 v[20:23], v[100:103], v[136:139], v[20:23]
    s_waitcnt lgkmcnt(4)
    s_nop 0
    v_mfma_f32_16x16x32_bf16 v[24:27], v[104:107], v[136:139], v[24:27]
    ds_read_b64_tr_b16 v[88:89], v202 offset:16384
    ds_read_b64_tr_b16 v[90:91], v202 offset:18432
    v_mfma_f32_16x16x32_bf16 v[40:43], v[104:107], v[140:143], v[40:43]
    ds_read_b64_tr_b16 v[92:93], v203 offset:16384
    ds_read_b64_tr_b16 v[94:95], v203 offset:18432
    v_mfma_f32_16x16x32_bf16 v[44:47], v[108:111], v[140:143], v[44:47]
    buffer_load_dwordx4 v[132:135], v12, s[52:55], s12 offen offset:1024 sc1
    v_mfma_f32_16x16x32_bf16 v[28:31], v[108:111], v[136:139], v[28:31]
    s_waitcnt vmcnt(6) lgkmcnt(4)
    s_nop 0
    v_mfma_f32_16x16x32_bf16 v[16:19], v[80:83], v[144:147], v[16:19]
    ds_read_b64_tr_b16 v[96:97], v200 offset:20480
    ds_read_b64_tr_b16 v[98:99], v200 offset:22528
    v_mfma_f32_16x16x32_bf16 v[32:35], v[80:83], v[148:151], v[32:35]
    ds_read_b64_tr_b16 v[100:101], v201 offset:20480
    ds_read_b64_tr_b16 v[102:103], v201 offset:22528
    v_mfma_f32_16x16x32_bf16 v[36:39], v[84:87], v[148:151], v[36:39]
    buffer_load_dwordx4 v[136:139], v15, s[52:55], s13 offen offset:0 sc1
    v_mfma_f32_16x16x32_bf16 v[20:23], v[84:87], v[144:147], v[20:23]
    s_waitcnt lgkmcnt(4)
    s_nop 0
    v_mfma_f32_16x16x32_bf16 v[24:27], v[88:91], v[144:147], v[24:27]
    ds_read_b64_tr_b16 v[104:105], v202 offset:20480
    ds_read_b64_tr_b16 v[106:107], v202 offset:22528
    v_mfma_f32_16x16x32_bf16 v[40:43], v[88:91], v[148:151], v[40:43]
    ds_read_b64_tr_b16 v[108:109], v203 offset:20480
    ds_read_b64_tr_b16 v[110:111], v203 offset:22528
    v_mfma_f32_16x16x32_bf16 v[44:47], v[92:95], v[148:151], v[44:47]
    buffer_load_dwordx4 v[140:143], v12, s[52:55], s13 offen offset:0 sc1
    v_mfma_f32_16x16x32_bf16 v[28:31], v[92:95], v[144:147], v[28:31]
    s_waitcnt vmcnt(6) lgkmcnt(4)
    s_nop 0
    v_mfma_f32_16x16x32_bf16 v[16:19], v[96:99], v[112:115], v[16:19]
    ds_read_b64_tr_b16 v[80:81], v200 offset:24576
    ds_read_b64_tr_b16 v[82:83], v200 offset:26624
    v_mfma_f32_16x16x32_bf16 v[32:35], v[96:99], v[116:119], v[32:35]
    ds_read_b64_tr_b16 v[84:85], v201 offset:24576
    ds_read_b64_tr_b16 v[86:87], v201 offset:26624
    v_mfma_f32_16x16x32_bf16 v[36:39], v[100:103], v[116:119], v[36:39]
    buffer_load_dwordx4 v[144:147], v15, s[52:55], s13 offen offset:1024 sc1
    v_mfma_f32_16x16x32_bf16 v[20:23], v[100:103], v[112:115], v[20:23]
    s_waitcnt lgkmcnt(4)
    s_nop 0
    v_mfma_f32_16x16x32_bf16 v[24:27], v[104:107], v[112:115], v[24:27]
    ds_read_b64_tr_b16 v[88:89], v202 offset:24576
    ds_read_b64_tr_b16 v[90:91], v202 offset:26624
    v_mfma_f32_16x16x32_bf16 v[40:43], v[104:107], v[116:119], v[40:43]
    ds_read_b64_tr_b16 v[92:93], v203 offset:24576
    ds_read_b64_tr_b16 v[94:95], v203 offset:26624
    v_mfma_f32_16x16x32_bf16 v[44:47], v[108:111], v[116:119], v[44:47]
    buffer_load_dwordx4 v[148:151], v12, s[52:55], s13 offen offset:1024 sc1
    v_mfma_f32_16x16x32_bf16 v[28:31], v[108:111], v[112:115], v[28:31]
    s_waitcnt vmcnt(6) lgkmcnt(4)
    s_nop 0
    v_mfma_f32_16x16x32_bf16 v[16:19], v[80:83], v[120:123], v[16:19]
    ds_read_b64_tr_b16 v[96:97], v200 offset:28672
    ds_read_b64_tr_b16 v[98:99], v200 offset:30720
    v_mfma_f32_16x16x32_bf16 v[32:35], v[80:83], v[124:127], v[32:35]
    ds_read_b64_tr_b16 v[100:101], v201 offset:28672
    ds_read_b64_tr_b16 v[102:103], v201 offset:30720
    v_mfma_f32_16x16x32_bf16 v[36:39], v[84:87], v[124:127], v[36:39]
    buffer_load_dwordx4 v[112:115], v15, s[52:55], s14 offen offset:0 sc1
    v_mfma_f32_16x16x32_bf16 v[20:23], v[84:87], v[120:123], v[20:23]
    s_waitcnt lgkmcnt(4)
    s_nop 0
    v_mfma_f32_16x16x32_bf16 v[24:27], v[88:91], v[120:123], v[24:27]
    ds_read_b64_tr_b16 v[104:105], v202 offset:28672
    ds_read_b64_tr_b16 v[106:107], v202 offset:30720
    v_mfma_f32_16x16x32_bf16 v[40:43], v[88:91], v[124:127], v[40:43]
    ds_read_b64_tr_b16 v[108:109], v203 offset:28672
    ds_read_b64_tr_b16 v[110:111], v203 offset:30720
    v_mfma_f32_16x16x32_bf16 v[44:47], v[92:95], v[124:127], v[44:47]
    buffer_load_dwordx4 v[116:119], v12, s[52:55], s14 offen offset:0 sc1
    v_mfma_f32_16x16x32_bf16 v[28:31], v[92:95], v[120:123], v[28:31]
    s_waitcnt vmcnt(6) lgkmcnt(4)
    s_nop 0
    s_mov_b32 s69, 3200000
lpoll_23:
    ds_read_b32 v14, v1 offset:48
    s_waitcnt lgkmcnt(0)
    v_cmp_ne_u32 vcc, 0, v14
    s_cmp_eq_u64 vcc, -1
    s_cbranch_scc1 lpolld_24
    s_sleep 1
    s_sub_u32 s69, s69, 1
    s_cmp_lg_u32 s69, 0
    s_cbranch_scc1 lpoll_23
lpolld_24:
    .p2align 3
    v_mfma_f32_16x16x32_bf16 v[16:19], v[96:99], v[128:131], v[16:19]
    ds_read_b64_tr_b16 v[80:81], v192 offset:40960
    ds_read_b64_tr_b16 v[82:83], v192 offset:43008
    v_mfma_f32_16x16x32_bf16 v[32:35], v[96:99], v[132:135], v[32:35]
    ds_read_b64_tr_b16 v[84:85], v193 offset:40960
    ds_read_b64_tr_b16 v[86:87], v193 offset:43008
    v_mfma_f32_16x16x32_bf16 v[36:39], v[100:103], v[132:135], v[36:39]
    buffer_load_dwordx4 v[120:123], v15, s[52:55], s14 offen offset:1024 sc1
    v_mfma_f32_16x16x32_bf16 v[20:23], v[100:103], v[128:131], v[20:23]
    s_waitcnt lgkmcnt(4)
    s_nop 0
    v_mfma_f32_16x16x32_bf16 v[24:27], v[104:107], v[128:131], v[24:27]
    ds_read_b64_tr_b16 v[88:89], v194 offset:40960
    ds_read_b64_tr_b16 v[90:91], v194 offset:43008
    v_mfma_f32_16x16x32_bf16 v[40:43], v[104:107], v[132:135], v[40:43]
    ds_read_b64_tr_b16 v[92:93], v195 offset:40960
    ds_read_b64_tr_b16 v[94:95], v195 offset:43008
    v_mfma_f32_16x16x32_bf16 v[44:47], v[108:111], v[132:135], v[44:47]
    buffer_load_dwordx4 v[124:127], v12, s[52:55], s14 offen offset:1024 sc1
    v_mfma_f32_16x16x32_bf16 v[28:31], v[108:111], v[128:131], v[28:31]
    s_waitcnt vmcnt(6) lgkmcnt(4)
    s_nop 0
    v_mfma_f32_16x16x32_bf16 v[16:19], v[80:83], v[136:139], v[16:19]
    ds_read_b64_tr_b16 v[96:97], v192 offset:45056
    ds_read_b64_tr_b16 v[98:99], v192 offset:47104
    v_mfma_f32_16x16x32_bf16 v[32:35], v[80:83], v[140:143], v[32:35]
    ds_read_b64_tr_b16 v[100:101], v193 offset:45056
    ds_read_b64_tr_b16 v[102:103], v193 offset:47104
    v_mfma_f32_16x16x32_bf16 v[36:39], v[84:87], v[140:143], v[36:39]
    buffer_load_dwordx4 v[128:131], v15, s[52:55], s15 offen offset:0 sc1
    v_mfma_f32_16x16x32_bf16 v[20:23], v[84:87], v[136:139], v[20:23]
    s_waitcnt lgkmcnt(4)
    s_nop 0
    v_mfma_f32_16x16x32_bf16 v[24:27], v[88:91], v[136:139], v[24:27]
    ds_read_b64_tr_b16 v[104:105], v194 offset:45056
    ds_read_b64_tr_b16 v[106:107], v194 offset:47104
    v_mfma_f32_16x16x32_bf16 v[40:43], v[88:91], v[140:143], v[40:43]
    ds_read_b64_tr_b16 v[108:109], v195 offset:45056
    ds_read_b64_tr_b16 v[110:111], v195 offset:47104
    v_mfma_f32_16x16x32_bf16 v[44:47], v[92:95], v[140:143], v[44:47]
    buffer_load_dwordx4 v[132:135], v12, s[52:55], s15 offen offset:0 sc1
    v_mfma_f32_16x16x32_bf16 v[28:31], v[92:95], v[136:139], v[28:31]
    s_waitcnt vmcnt(6) lgkmcnt(4)
    s_nop 0
    v_mfma_f32_16x16x32_bf16 v[16:19], v[96:99], v[144:147], v[16:19]
    ds_read_b64_tr_b16 v[80:81], v192 offset:49152
    ds_read_b64_tr_b16 v[82:83], v192 offset:51200
    v_mfma_f32_16x16x32_bf16 v[32:35], v[96:99], v[148:151], v[32:35]
    ds_read_b64_tr_b16 v[84:85], v193 offset:49152
    ds_read_b64_tr_b16 v[86:87], v193 offset:51200
    v_mfma_f32_16x16x32_bf16 v[36:39], v[100:103], v[148:151], v[36:39]
    buffer_load_dwordx4 v[136:139], v15, s[52:55], s15 offen offset:1024 sc1
    v_mfma_f32_16x16x32_bf16 v[20:23], v[100:103], v[144:147], v[20:23]
    s_waitcnt lgkmcnt(4)
    s_nop 0
    v_mfma_f32_16x16x32_bf16 v[24:27], v[104:107], v[144:147], v[24:27]
    ds_read_b64_tr_b16 v[88:89], v194 offset:49152
    ds_read_b64_tr_b16 v[90:91], v194 offset:51200
    v_mfma_f32_16x16x32_bf16 v[40:43], v[104:107], v[148:151], v[40:43]
    ds_read_b64_tr_b16 v[92:93], v195 offset:49152
    ds_read_b64_tr_b16 v[94:95], v195 offset:51200
    v_mfma_f32_16x16x32_bf16 v[44:47], v[108:111], v[148:151], v[44:47]
    buffer_load_dwordx4 v[140:143], v12, s[52:55], s15 offen offset:1024 sc1
    v_mfma_f32_16x16x32_bf16 v[28:31], v[108:111], v[144:147], v[28:31]
    s_waitcnt vmcnt(6) lgkmcnt(4)
    s_nop 0
    v_mfma_f32_16x16x32_bf16 v[16:19], v[80:83], v[112:115], v[16:19]
    ds_read_b64_tr_b16 v[96:97], v192 offset:53248
    ds_read_b64_tr_b16 v[98:99], v192 offset:55296
    v_mfma_f32_16x16x32_bf16 v[32:35], v[80:83], v[116:119], v[32:35]
    ds_read_b64_tr_b16 v[100:101], v193 offset:53248
    ds_read_b64_tr_b16 v[102:103], v193 offset:55296
    v_mfma_f32_16x16x32_bf16 v[36:39], v[84:87], v[116:119], v[36:39]
    buffer_load_dwordx4 v[144:147], v15, s[52:55], s16 offen offset:0 sc1
    v_mfma_f32_16x16x32_bf16 v[20:23], v[84:87], v[112:115], v[20:23]
    s_waitcnt lgkmcnt(4)
    s_nop 0
    v_mfma_f32_16x16x32_bf16 v[24:27], v[88:91], v[112:115], v[24:27]
    ds_read_b64_tr_b16 v[104:105], v194 offset:53248
    ds_read_b64_tr_b16 v[106:107], v194 offset:55296
    v_mfma_f32_16x16x32_bf16 v[40:43], v[88:91], v[116:119], v[40:43]
    ds_read_b64_tr_b16 v[108:109], v195 offset:53248
    ds_read_b64_tr_b16 v[110:111], v195 offset:55296
    v_mfma_f32_16x16x32_bf16 v[44:47], v[92:95], v[116:119], v[44:47]
    buffer_load_dwordx4 v[148:151], v12, s[52:55], s16 offen offset:0 sc1
    v_mfma_f32_16x16x32_bf16 v[28:31], v[92:95], v[112:115], v[28:31]
    s_waitcnt vmcnt(6) lgkmcnt(4)
    s_nop 0
    v_mfma_f32_16x16x32_bf16 v[16:19], v[96:99], v[120:123], v[16:19]
    ds_read_b64_tr_b16 v[80:81], v192 offset:57344
    ds_read_b64_tr_b16 v[82:83], v192 offset:59392
    v_mfma_f32_16x16x32_bf16 v[32:35], v[96:99], v[124:127], v[32:35]
    ds_read_b64_tr_b16 v[84:85], v193 offset:57344
    ds_read_b64_tr_b16 v[86:87], v193 offset:59392
    v_mfma_f32_16x16x32_bf16 v[36:39], v[100:103], v[124:127], v[36:39]
    buffer_load_dwordx4 v[112:115], v15, s[52:55], s16 offen offset:1024 sc1
    v_mfma_f32_16x16x32_bf16 v[20:23], v[100:103], v[120:123], v[20:23]
    s_waitcnt lgkmcnt(4)
    s_nop 0
    v_mfma_f32_16x16x32_bf16 v[24:27], v[104:107], v[120:123], v[24:27]
    ds_read_b64_tr_b16 v[88:89], v194 offset:57344
    ds_read_b64_tr_b16 v[90:91], v194 offset:59392
    v_mfma_f32_16x16x32_bf16 v[40:43], v[104:107], v[124:127], v[40:43]
    ds_read_b64_tr_b16 v[92:93], v195 offset:57344
    ds_read_b64_tr_b16 v[94:95], v195 offset:59392
    v_mfma_f32_16x16x32_bf16 v[44:47], v[108:111], v[124:127], v[44:47]
    buffer_load_dwordx4 v[116:119], v12, s[52:55], s16 offen offset:1024 sc1
    v_mfma_f32_16x16x32_bf16 v[28:31], v[108:111], v[120:123], v[28:31]
    s_waitcnt vmcnt(6) lgkmcnt(4)
    s_nop 0
    v_mfma_f32_16x16x32_bf16 v[16:19], v[80:83], v[128:131], v[16:19]
    ds_read_b64_tr_b16 v[96:97], v192 offset:61440
    ds_read_b64_tr_b16 v[98:99], v192 offset:63488
    v_mfma_f32_16x16x32_bf16 v[32:35], v[80:83], v[132:135], v[32:35]
    ds_read_b64_tr_b16 v[100:101], v193 offset:61440
    ds_read_b64_tr_b16 v[102:103], v193 offset:63488
    v_mfma_f32_16x16x32_bf16 v[36:39], v[84:87], v[132:135], v[36:39]
    buffer_load_dwordx4 v[120:123], v15, s[52:55], s17 offen offset:0 sc1
    v_mfma_f32_16x16x32_bf16 v[20:23], v[84:87], v[128:131], v[20:23]
    s_waitcnt lgkmcnt(4)
    s_nop 0
    v_mfma_f32_16x16x32_bf16 v[24:27], v[88:91], v[128:131], v[24:27]
    ds_read_b64_tr_b16 v[104:105], v194 offset:61440
    ds_read_b64_tr_b16 v[106:107], v194 offset:63488
    v_mfma_f32_16x16x32_bf16 v[40:43], v[88:91], v[132:135], v[40:43]
    ds_read_b64_tr_b16 v[108:109], v195 offset:61440
    ds_read_b64_tr_b16 v[110:111], v195 offset:63488
    v_mfma_f32_16x16x32_bf16 v[44:47], v[92:95], v[132:135], v[44:47]
    buffer_load_dwordx4 v[124:127], v12, s[52:55], s17 offen offset:0 sc1
    v_mfma_f32_16x16x32_bf16 v[28:31], v[92:95], v[128:131], v[28:31]
    s_waitcnt vmcnt(6) lgkmcnt(4)
    s_nop 0
    v_mfma_f32_16x16x32_bf16 v[16:19], v[96:99], v[136:139], v[16:19]
    ds_read_b64_tr_b16 v[80:81], v196 offset:0
    ds_read_b64_tr_b16 v[82:83], v196 offset:2048
    v_mfma_f32_16x16x32_bf16 v[32:35], v[96:99], v[140:143], v[32:35]
    ds_read_b64_tr_b16 v[84:85], v197 offset:0
    ds_read_b64_tr_b16 v[86:87], v197 offset:2048
    v_mfma_f32_16x16x32_bf16 v[36:39], v[100:103], v[140:143], v[36:39]
    buffer_load_dwordx4 v[128:131], v15, s[52:55], s17 offen offset:1024 sc1
    v_mfma_f32_16x16x32_bf16 v[20:23], v[100:103], v[136:139], v[20:23]
    s_waitcnt lgkmcnt(4)
    s_nop 0
    v_mfma_f32_16x16x32_bf16 v[24:27], v[104:107], v[136:139], v[24:27]
    ds_read_b64_tr_b16 v[88:89], v198 offset:0
    ds_read_b64_tr_b16 v[90:91], v198 offset:2048
    v_mfma_f32_16x16x32_bf16 v[40:43], v[104:107], v[140:143], v[40:43]
    ds_read_b64_tr_b16 v[92:93], v199 offset:0
    ds_read_b64_tr_b16 v[94:95], v199 offset:2048
    v_mfma_f32_16x16x32_bf16 v[44:47], v[108:111], v[140:143], v[44:47]
    buffer_load_dwordx4 v[132:135], v12, s[52:55], s17 offen offset:1024 sc1
    v_mfma_f32_16x16x32_bf16 v[28:31], v[108:111], v[136:139], v[28:31]
    s_waitcnt vmcnt(6) lgkmcnt(4)
    s_nop 0
    v_mfma_f32_16x16x32_bf16 v[16:19], v[80:83], v[144:147], v[16:19]
    ds_read_b64_tr_b16 v[96:97], v196 offset:4096
    ds_read_b64_tr_b16 v[98:99], v196 offset:6144
    v_mfma_f32_16x16x32_bf16 v[32:35], v[80:83], v[148:151], v[32:35]
    ds_read_b64_tr_b16 v[100:101], v197 offset:4096
    ds_read_b64_tr_b16 v[102:103], v197 offset:6144
    v_mfma_f32_16x16x32_bf16 v[36:39], v[84:87], v[148:151], v[36:39]
    buffer_load_dwordx4 v[136:139], v15, s[52:55], s18 offen offset:0 sc1
    v_mfma_f32_16x16x32_bf16 v[20:23], v[84:87], v[144:147], v[20:23]
    s_waitcnt lgkmcnt(4)
    s_nop 0
    v_mfma_f32_16x16x32_bf16 v[24:27], v[88:91], v[144:147], v[24:27]
    ds_read_b64_tr_b16 v[104:105], v198 offset:4096
    ds_read_b64_tr_b16 v[106:107], v198 offset:6144
    v_mfma_f32_16x16x32_bf16 v[40:43], v[88:91], v[148:151], v[40:43]
    ds_read_b64_tr_b16 v[108:109], v199 offset:4096
    ds_read_b64_tr_b16 v[110:111], v199 offset:6144
    v_mfma_f32_16x16x32_bf16 v[44:47], v[92:95], v[148:151], v[44:47]
    buffer_load_dwordx4 v[140:143], v12, s[52:55], s18 offen offset:0 sc1
    v_mfma_f32_16x16x32_bf16 v[28:31], v[92:95], v[144:147], v[28:31]
    s_waitcnt vmcnt(6) lgkmcnt(4)
    s_nop 0
    v_mfma_f32_16x16x32_bf16 v[16:19], v[96:99], v[112:115], v[16:19]
    ds_read_b64_tr_b16 v[80:81], v196 offset:8192
    ds_read_b64_tr_b16 v[82:83], v196 offset:10240
    v_mfma_f32_16x16x32_bf16 v[32:35], v[96:99], v[116:119], v[32:35]
    ds_read_b64_tr_b16 v[84:85], v197 offset:8192
    ds_read_b64_tr_b16 v[86:87], v197 offset:10240
    v_mfma_f32_16x16x32_bf16 v[36:39], v[100:103], v[116:119], v[36:39]
    buffer_load_dwordx4 v[144:147], v15, s[52:55], s18 offen offset:1024 sc1
    v_mfma_f32_16x16x32_bf16 v[20:23], v[100:103], v[112:115], v[20:23]
    s_waitcnt lgkmcnt(4)
    s_nop 0
    v_mfma_f32_16x16x32_bf16 v[24:27], v[104:107], v[112:115], v[24:27]
    ds_read_b64_tr_b16 v[88:89], v198 offset:8192
    ds_read_b64_tr_b16 v[90:91], v198 offset:10240
    v_mfma_f32_16x16x32_bf16 v[40:43], v[104:107], v[116:119], v[40:43]
    ds_read_b64_tr_b16 v[92:93], v199 offset:8192
    ds_read_b64_tr_b16 v[94:95], v199 offset:10240
    v_mfma_f32_16x16x32_bf16 v[44:47], v[108:111], v[116:119], v[44:47]
    buffer_load_dwordx4 v[148:151], v12, s[52:55], s18 offen offset:1024 sc1
    v_mfma_f32_16x16x32_bf16 v[28:31], v[108:111], v[112:115], v[28:31]
    s_waitcnt vmcnt(6) lgkmcnt(4)
    s_nop 0
    v_mfma_f32_16x16x32_bf16 v[16:19], v[80:83], v[120:123], v[16:19]
    ds_read_b64_tr_b16 v[96:97], v196 offset:12288
    ds_read_b64_tr_b16 v[98:99], v196 offset:14336
    v_mfma_f32_16x16x32_bf16 v[32:35], v[80:83], v[124:127], v[32:35]
    ds_read_b64_tr_b16 v[100:101], v197 offset:12288
    ds_read_b64_tr_b16 v[102:103], v197 offset:14336
    v_mfma_f32_16x16x32_bf16 v[36:39], v[84:87], v[124:127], v[36:39]
    buffer_load_dwordx4 v[112:115], v15, s[52:55], s19 offen offset:0 sc1
    v_mfma_f32_16x16x32_bf16 v[20:23], v[84:87], v[120:123], v[20:23]
    s_waitcnt lgkmcnt(4)
    s_nop 0
    v_mfma_f32_16x16x32_bf16 v[24:27], v[88:91], v[120:123], v[24:27]
    ds_read_b64_tr_b16 v[104:105], v198 offset:12288
    ds_read_b64_tr_b16 v[106:107], v198 offset:14336
    v_mfma_f32_16x16x32_bf16 v[40:43], v[88:91], v[124:127], v[40:43]
    ds_read_b64_tr_b16 v[108:109], v199 offset:12288
    ds_read_b64_tr_b16 v[110:111], v199 offset:14336
    v_mfma_f32_16x16x32_bf16 v[44:47], v[92:95], v[124:127], v[44:47]
    buffer_load_dwordx4 v[116:119], v12, s[52:55], s19 offen offset:0 sc1
    v_mfma_f32_16x16x32_bf16 v[28:31], v[92:95], v[120:123], v[28:31]
    s_waitcnt vmcnt(6) lgkmcnt(4)
    s_nop 0
    ds_write_b32 v4, v6 offset:160
    v_mfma_f32_16x16x32_bf16 v[16:19], v[96:99], v[128:131], v[16:19]
    ds_read_b64_tr_b16 v[80:81], v192 offset:1024
    ds_read_b64_tr_b16 v[82:83], v192 offset:3072
    v_mfma_f32_16x16x32_bf16 v[32:35], v[96:99], v[132:135], v[32:35]
    ds_read_b64_tr_b16 v[84:85], v193 offset:1024
    ds_read_b64_tr_b16 v[86:87], v193 offset:3072
    v_mfma_f32_16x16x32_bf16 v[36:39], v[100:103], v[132:135], v[36:39]
    buffer_load_dwordx4 v[120:123], v15, s[52:55], s19 offen offset:1024 sc1
    v_mfma_f32_16x16x32_bf16 v[20:23], v[100:103], v[128:131], v[20:23]
    s_waitcnt lgkmcnt(4)
    s_nop 0
    v_mfma_f32_16x16x32_bf16 v[24:27], v[104:107], v[128:131], v[24:27]
    ds_read_b64_tr_b16 v[88:89], v194 offset:1024
    ds_read_b64_tr_b16 v[90:91], v194 offset:3072
    v_mfma_f32_16x16x32_bf16 v[40:43], v[104:107], v[132:135], v[40:43]
    ds_read_b64_tr_b16 v[92:93], v195 offset:1024
    ds_read_b64_tr_b16 v[94:95], v195 offset:3072
    v_mfma_f32_16x16x32_bf16 v[44:47], v[108:111], v[132:135], v[44:47]
    buffer_load_dwordx4 v[124:127], v12, s[52:55], s19 offen offset:1024 sc1
    v_mfma_f32_16x16x32_bf16 v[28:31], v[108:111], v[128:131], v[28:31]
    s_waitcnt vmcnt(6) lgkmcnt(4)
    s_nop 0
    v_mfma_f32_16x16x32_bf16 v[16:19], v[80:83], v[136:139], v[16:19]
    ds_read_b64_tr_b16 v[96:97], v192 offset:5888
    ds_read_b64_tr_b16 v[98:99], v192 offset:7936
    v_mfma_f32_16x16x32_bf16 v[32:35], v[80:83], v[140:143], v[32:35]
    ds_read_b64_tr_b16 v[100:101], v193 offset:5888
    ds_read_b64_tr_b16 v[102:103], v193 offset:7936
    v_mfma_f32_16x16x32_bf16 v[36:39], v[84:87], v[140:143], v[36:39]
    v_mfma_f32_16x16x32_bf16 v[20:23], v[84:87], v[136:139], v[20:23]
    s_waitcnt lgkmcnt(4)
    s_nop 0
    v_mfma_f32_16x16x32_bf16 v[24:27], v[88:91], v[136:139], v[24:27]
    ds_read_b64_tr_b16 v[104:105], v194 offset:5888
    ds_read_b64_tr_b16 v[106:107], v194 offset:7936
    v_mfma_f32_16x16x32_bf16 v[40:43], v[88:91], v[140:143], v[40:43]
    ds_read_b64_tr_b16 v[108:109], v195 offset:5888
    ds_read_b64_tr_b16 v[110:111], v195 offset:7936
    v_mfma_f32_16x16x32_bf16 v[44:47], v[92:95], v[140:143], v[44:47]
    v_mfma_f32_16x16x32_bf16 v[28:31], v[92:95], v[136:139], v[28:31]
    s_waitcnt vmcnt(4) lgkmcnt(4)
    s_nop 0
    v_mfma_f32_16x16x32_bf16 v[16:19], v[96:99], v[144:147], v[16:19]
    ds_read_b64_tr_b16 v[80:81], v192 offset:10752
    ds_read_b64_tr_b16 v[82:83], v192 offset:12800
    v_mfma_f32_16x16x32_bf16 v[32:35], v[96:99], v[148:151], v[32:35]
    ds_read_b64_tr_b16 v[84:85], v193 offset:10752
    ds_read_b64_tr_b16 v[86:87], v193 offset:12800
    v_mfma_f32_16x16x32_bf16 v[36:39], v[100:103], v[148:151], v[36:39]
    v_mfma_f32_16x16x32_bf16 v[20:23], v[100:103], v[144:147], v[20:23]
    s_waitcnt lgkmcnt(4)
    s_nop 0
    v_mfma_f32_16x16x32_bf16 v[24:27], v[104:107], v[144:147], v[24:27]
    ds_read_b64_tr_b16 v[88:89], v194 offset:10752
    ds_read_b64_tr_b16 v[90:91], v194 offset:12800
    v_mfma_f32_16x16x32_bf16 v[40:43], v[104:107], v[148:151], v[40:43]
    ds_read_b64_tr_b16 v[92:93], v195 offset:10752
    ds_read_b64_tr_b16 v[94:95], v195 offset:12800
    v_mfma_f32_16x16x32_bf16 v[44:47], v[108:111], v[148:151], v[44:47]
    v_mfma_f32_16x16x32_bf16 v[28:31], v[108:111], v[144:147], v[28:31]
    s_waitcnt vmcnt(2) lgkmcnt(4)
    s_nop 0
    v_mfma_f32_16x16x32_bf16 v[16:19], v[80:83], v[112:115], v[16:19]
    ds_read_b64_tr_b16 v[96:97], v192 offset:15616
    ds_read_b64_tr_b16 v[98:99], v192 offset:17664
    v_mfma_f32_16x16x32_bf16 v[32:35], v[80:83], v[116:119], v[32:35]
    ds_read_b64_tr_b16 v[100:101], v193 offset:15616
    ds_read_b64_tr_b16 v[102:103], v193 offset:17664
    v_mfma_f32_16x16x32_bf16 v[36:39], v[84:87], v[116:119], v[36:39]
    v_mfma_f32_16x16x32_bf16 v[20:23], v[84:87], v[112:115], v[20:23]
    s_waitcnt lgkmcnt(4)
    s_nop 0
    v_mfma_f32_16x16x32_bf16 v[24:27], v[88:91], v[112:115], v[24:27]
    ds_read_b64_tr_b16 v[104:105], v194 offset:15616
    ds_read_b64_tr_b16 v[106:107], v194 offset:17664
    v_mfma_f32_16x16x32_bf16 v[40:43], v[88:91], v[116:119], v[40:43]
    ds_read_b64_tr_b16 v[108:109], v195 offset:15616
    ds_read_b64_tr_b16 v[110:111], v195 offset:17664
    v_mfma_f32_16x16x32_bf16 v[44:47], v[92:95], v[116:119], v[44:47]
    v_mfma_f32_16x16x32_bf16 v[28:31], v[92:95], v[112:115], v[28:31]
    s_waitcnt vmcnt(0) lgkmcnt(4)
    s_nop 0
    v_mfma_f32_16x16x32_bf16 v[16:19], v[96:99], v[120:123], v[16:19]
    v_mfma_f32_16x16x32_bf16 v[32:35], v[96:99], v[124:127], v[32:35]
    v_mfma_f32_16x16x32_bf16 v[36:39], v[100:103], v[124:127], v[36:39]
    v_mfma_f32_16x16x32_bf16 v[20:23], v[100:103], v[120:123], v[20:23]
    s_waitcnt lgkmcnt(0)
    s_nop 0
    v_mfma_f32_16x16x32_bf16 v[24:27], v[104:107], v[120:123], v[24:27]
    v_mfma_f32_16x16x32_bf16 v[40:43], v[104:107], v[124:127], v[40:43]
    v_mfma_f32_16x16x32_bf16 v[44:47], v[108:111], v[124:127], v[44:47]
    v_mfma_f32_16x16x32_bf16 v[28:31], v[108:111], v[120:123], v[28:31]
    v_cvt_pk_bf16_f32 v48, v16, v17
    v_cvt_pk_bf16_f32 v49, v18, v19
    v_cvt_pk_bf16_f32 v50, v20, v21
    v_cvt_pk_bf16_f32 v51, v22, v23
    s_nop 0
    v_cvt_pk_bf16_f32 v52, v24, v25
    v_cvt_pk_bf16_f32 v53, v26, v27
    s_nop 0
    v_cvt_pk_bf16_f32 v54, v28, v29
    v_cvt_pk_bf16_f32 v55, v30, v31
    v_permlane16_swap_b32 v48, v50
    v_permlane16_swap_b32 v49, v51
    v_permlane16_swap_b32 v52, v54
    v_permlane16_swap_b32 v53, v55
    v_mov_b32 v56, v52
    v_mov_b32 v57, v53
    v_mov_b32 v58, v54
    v_mov_b32 v59, v55
    v_mov_b32_dpp v52, v48 row_ror:8 row_mask:0xf bank_mask:0x3
    v_mov_b32_dpp v53, v49 row_ror:8 row_mask:0xf bank_mask:0x3
    v_mov_b32_dpp v54, v50 row_ror:8 row_mask:0xf bank_mask:0x3
    v_mov_b32_dpp v55, v51 row_ror:8 row_mask:0xf bank_mask:0x3
    v_mov_b32_dpp v48, v56 row_ror:8 row_mask:0xf bank_mask:0xc
    v_mov_b32_dpp v49, v57 row_ror:8 row_mask:0xf bank_mask:0xc
    v_mov_b32_dpp v50, v58 row_ror:8 row_mask:0xf bank_mask:0xc
    v_mov_b32_dpp v51, v59 row_ror:8 row_mask:0xf bank_mask:0xc
    buffer_store_dwordx4 v[48:51], v2, s[56:59], s74 offen nt
    s_add_u32 s68, s74, 32768
    buffer_store_dwordx4 v[52:55], v2, s[56:59], s68 offen nt
    v_cvt_pk_bf16_f32 v64, v32, v33
    v_cvt_pk_bf16_f32 v65, v34, v35
    v_cvt_pk_bf16_f32 v66, v36, v37
    v_cvt_pk_bf16_f32 v67, v38, v39
    v_cvt_pk_bf16_f32 v68, v40, v41
    v_cvt_pk_bf16_f32 v69, v42, v43
    v_cvt_pk_bf16_f32 v70, v44, v45
    v_cvt_pk_bf16_f32 v71, v46, v47
    v_permlane16_swap_b32 v64, v66
    v_permlane16_swap_b32 v65, v67
    v_permlane16_swap_b32 v68, v70
    v_permlane16_swap_b32 v69, v71
    v_mov_b32 v72, v68
    v_mov_b32 v73, v69
    v_mov_b32 v74, v70
    v_mov_b32 v75, v71
    v_mov_b32_dpp v68, v64 row_ror:8 row_mask:0xf bank_mask:0x3
    v_mov_b32_dpp v69, v65 row_ror:8 row_mask:0xf bank_mask:0x3
    v_mov_b32_dpp v70, v66 row_ror:8 row_mask:0xf bank_mask:0x3
    v_mov_b32_dpp v71, v67 row_ror:8 row_mask:0xf bank_mask:0x3
    v_mov_b32_dpp v64, v72 row_ror:8 row_mask:0xf bank_mask:0xc
    v_mov_b32_dpp v65, v73 row_ror:8 row_mask:0xf bank_mask:0xc
    v_mov_b32_dpp v66, v74 row_ror:8 row_mask:0xf bank_mask:0xc
    v_mov_b32_dpp v67, v75 row_ror:8 row_mask:0xf bank_mask:0xc
    buffer_store_dwordx4 v[64:67], v2, s[56:59], s75 offen nt
    s_add_u32 s68, s75, 32768
    buffer_store_dwordx4 v[68:71], v2, s[56:59], s68 offen nt
    s_endpgm
L_S:
    s_and_b32 s68, s60, 3
    s_lshl_b32 s68, s68, 2
    s_and_b32 s69, s61, 3
    s_add_u32 s62, s68, s69
    s_lshr_b32 s68, s60, 2
    s_lshl_b32 s68, s68, 3
    s_lshr_b32 s70, s61, 2
    s_add_u32 s63, s68, s70
    s_add_u32 s67, s69, s70
    s_lshl_b32 s68, s60, 1
    s_add_u32 s69, s65, s68
    s_lshl_b32 s69, s69, 0
    s_and_b32 s100, s69, 15
    s_mov_b32 s34, s64
    s_mov_b32 s35, s65
    s_sub_u32 s66, s66, 4
    v_lshrrev_b32 v3, 3, v0
    v_and_b32 v4, 7, v0
    s_lshl_b32 s68, s63, 7
    s_lshl_b32 s69, s66, 5
    s_add_u32 s68, s68, s69
    v_add_u32 v5, s68, v3
    v_lshlrev_b32 v5, 11, v5
    v_lshrrev_b32 v6, 4, v0
    v_xor_b32 v6, v6, v4
    v_lshl_add_u32 v10, v6, 4, v5
    v_xor_b32_e64 v11, 64, v10
    v_add_u32 v11, 16384, v11
    v_add_u32 v12, 32768, v10
    v_add_u32 v13, 32768, v11
    s_lshl_b32 s68, s66, 4
    v_add_u32 v5, s68, v3
    v_mul_u32_u24 v5, 6144, v5
    v_bfe_u32 v6, v0, 4, 1
    v_lshlrev_b32 v6, 1, v6
    v_xor_b32 v16, v6, v4
    v_lshl_add_u32 v5, v16, 4, v5
    s_lshl_b32 s68, s62, 7
    v_add_u32 v14, s68, v5
    v_xor_b32_e64 v15, 64, v14
    v_add_u32 v15, 49152, v15
    s_lshl_b32 s68, s65, 7
    s_add_u32 s68, s68, s69
    v_add_u32 v5, s68, v3
    v_lshlrev_b32 v5, 11, v5
    v_lshl_add_u32 v8, v16, 4, v5
    v_xor_b32 v9, 64, v8
    s_mul_i32 s81, s60, 2
    s_lshl_b32 s77, s66, 12
    s_lshl_b32 s73, s66, 11
    s_add_u32 s79, s77, 83968
    s_mul_i32 s80, s66, 4864
    s_add_u32 s80, s80, 1024
    s_mov_b32 s38, 4194304
    s_mov_b32 s39, 0x20000
    s_mov_b32 s42, 6291456
    s_mov_b32 s43, 0x20000
    s_mov_b32 s46, 2097152
    s_mov_b32 s47, 0x20000
    s_mov_b32 s50, 4194304
    s_mov_b32 s51, 0x20000
    s_mov_b32 s54, 16777216
    s_mov_b32 s55, 0x20000
    s_mov_b32 s58, 8388608
    s_mov_b32 s59, 0x20000
    s_waitcnt lgkmcnt(0)
    s_mov_b64 s[36:37], s[4:5]
    s_mov_b64 s[40:41], s[6:7]
    s_mov_b64 s[44:45], s[8:9]
    s_mov_b64 s[48:49], s[10:11]
    s_mov_b64 s[52:53], s[32:33]
    s_mov_b64 s[56:57], s[28:29]
    s_cmp_ge_u32 s2, 16
    s_cbranch_scc1 L_nz
    v_mov_b32 v32, 0
    v_mov_b32 v33, 0
    v_mov_b32 v34, 0
    v_mov_b32 v35, 0
    v_lshlrev_b32_e64 v2, 4, v0
    s_lshl_b32 s68, s66, 15
    s_lshl_b32 s69, s2, 11
    s_add_u32 s68, s68, s69
    buffer_store_dwordx4 v[32:35], v2, s[52:55], s68 offen offset:0 sc1
    buffer_store_dwordx4 v[32:35], v2, s[52:55], s68 offen offset:1024 sc1
L_nz:
    s_add_u32 s68, s67, 0
    s_and_b32 s68, s68, 3
    s_add_u32 s68, s68, s81
    s_add_u32 s68, s68, 0
    s_and_b32 s68, s68, 15
    s_lshl_b32 s75, s68, 7
    s_mul_i32 s76, s68, 393216
    s_add_u32 m0, s77, 40960
    s_nop 0
    buffer_load_dwordx4 v10, s[36:39], s75 offen lds
    v_lshrrev_b32 v6, 4, v0
    v_lshlrev_b32 v6, 1, v6
    v_xor_b32 v6, v6, v4
    v_lshlrev_b32_e64 v17, 11, v3
    s_add_u32 m0, s77, 41984
    s_nop 0
    buffer_load_dwordx4 v11, s[36:39], s75 offen lds
    v_lshl_add_u32 v17, v6, 4, v17
    s_lshl_b32 s72, s35, 7
    v_add_u32 v17, s72, v17
    s_lshl_b32 s71, s100, 3
    s_add_u32 m0, s77, 43008
    s_nop 0
    buffer_load_dwordx4 v12, s[36:39], s75 offen lds
    s_add_u32 s71, s71, s66
    s_lshl_b32 s71, s71, 14
    s_lshl_b32 s70, s66, 10
    s_add_u32 s5, s71, 1179648
    s_add_u32 m0, s77, 44032
    s_nop 0
    buffer_load_dwordx4 v13, s[36:39], s75 offen lds
    s_lshl_b32 s6, s100, 1
    s_add_u32 s6, s6, s66
    s_add_u32 s6, s6, 28
    s_and_b32 s6, s6, 31
    s_add_u32 m0, s73, 65536
    s_add_u32 s68, s76, 2048
    buffer_load_dwordx4 v14, s[40:43], s68 offen lds
    s_lshl_b32 s6, s6, 16
    v_and_b32 v7, 3, v0
    v_lshlrev_b32 v7, 2, v7
    v_lshrrev_b32_e64 v5, 4, v0
    s_add_u32 m0, s73, 66560
    s_add_u32 s68, s76, 2048
    buffer_load_dwordx4 v15, s[40:43], s68 offen lds
    v_bfe_u32 v6, v0, 2, 2
    v_lshl_add_u32 v2, v5, 3, v6
    v_lshlrev_b32_e64 v2, 7, v2
    v_lshl_add_u32 v2, v7, 1, v2
    s_add_u32 m0, s73, 73728
    s_add_u32 s68, s76, 4096
    buffer_load_dwordx4 v14, s[40:43], s68 offen lds
    v_bfe_u32 v30, v0, 3, 2
    v_lshl_add_u32 v2, v30, 5, v2
    s_add_u32 s72, s77, 122880
    v_add_u32_e64 v20, s72, v2
    s_add_u32 m0, s73, 74752
    s_add_u32 s68, s76, 4096
    buffer_load_dwordx4 v15, s[40:43], s68 offen lds
    v_xor_b32 v21, 32, v20
    v_xor_b32 v22, 64, v20
    v_xor_b32 v23, 96, v20
    v_lshlrev_b32_e64 v6, 14, v6
    s_add_u32 m0, s73, 57344
    s_add_u32 s68, s76, 0
    buffer_load_dwordx4 v14, s[40:43], s68 offen lds
    v_lshl_add_u32 v6, v5, 6, v6
    v_add_lshl_u32 v5, v0, s66, 4
    v_and_or_b32 v24, v5, 48, v6
    s_add_u32 m0, s73, 58368
    s_add_u32 s68, s76, 0
    buffer_load_dwordx4 v15, s[40:43], s68 offen lds
    s_lshl_b32 s68, s64, 7
    s_add_u32 m0, s77, 122880
    s_nop 0
    buffer_load_dwordx4 v8, s[48:51], s68 offen nt lds
    s_add_u32 s68, s68, 16384
    s_add_u32 m0, s77, 123904
    s_nop 0
    buffer_load_dwordx4 v9, s[48:51], s68 offen nt lds
    s_add_u32 s68, s68, 16384
    s_add_u32 m0, s77, 124928
    s_nop 0
    buffer_load_dwordx4 v8, s[48:51], s68 offen nt lds
    s_add_u32 s68, s68, 16384
    s_add_u32 m0, s77, 125952
    s_nop 0
    buffer_load_dwordx4 v9, s[48:51], s68 offen nt lds
    s_add_u32 s68, s68, 16384
    s_add_u32 s68, s67, 1
    s_and_b32 s68, s68, 3
    s_add_u32 s68, s68, s81
    s_add_u32 s68, s68, 0
    s_and_b32 s68, s68, 15
    s_lshl_b32 s75, s68, 7
    s_mul_i32 s76, s68, 393216
    s_add_u32 m0, s77, 81920
    s_nop 0
    buffer_load_dwordx4 v10, s[36:39], s75 offen lds
    s_and_b32 s72, s61, 3
    s_lshr_b32 s69, s61, 2
    s_add_u32 m0, s77, 82944
    s_nop 0
    buffer_load_dwordx4 v11, s[36:39], s75 offen lds
    s_mul_i32 s69, s69, 3
    s_add_u32 s69, s69, s72
    s_add_u32 m0, s77, 83968
    s_nop 0
    buffer_load_dwordx4 v12, s[36:39], s75 offen lds
    s_lshl_b32 s69, s69, 2
    s_add_u32 s69, s69, s66
    s_add_u32 m0, s77, 84992
    s_nop 0
    buffer_load_dwordx4 v13, s[36:39], s75 offen lds
    s_lshl_b32 s69, s69, 14
    s_or_b32 s72, s62, 3
    s_add_u32 m0, s73, 106496
    s_add_u32 s68, s76, 2048
    buffer_load_dwordx4 v14, s[40:43], s68 offen lds
    s_lshl_b32 s72, s72, 7
    s_add_u32 s69, s69, s72
    s_add_u32 m0, s73, 107520
    s_add_u32 s68, s76, 2048
    buffer_load_dwordx4 v15, s[40:43], s68 offen lds
    s_and_b32 s72, s62, 7
    s_cmp_lt_u32 s72, 3
    s_nop 0
    s_cselect_b32 s69, s69, 0x7000000
    s_add_u32 m0, s73, 114688
    s_add_u32 s68, s76, 4096
    buffer_load_dwordx4 v14, s[40:43], s68 offen lds
    v_lshl_add_u32 v19, v4, 11, s69
    v_lshl_add_u32 v19, v3, 26, v19
    s_add_u32 m0, s73, 115712
    s_add_u32 s68, s76, 4096
    buffer_load_dwordx4 v15, s[40:43], s68 offen lds
    s_lshl_b32 s74, s64, 11
    s_add_u32 s74, s74, 65536
    s_add_u32 m0, s73, 98304
    s_add_u32 s68, s76, 0
    buffer_load_dwordx4 v14, s[40:43], s68 offen lds
    v_lshlrev_b32_e64 v1, 2, v0
    s_add_u32 m0, s73, 99328
    s_add_u32 s68, s76, 0
    buffer_load_dwordx4 v15, s[40:43], s68 offen lds
    s_lshl_b32 s68, s64, 18
    s_lshl_b32 s69, s65, 10
    s_add_u32 s68, s68, s69
    s_lshl_b32 s69, s66, 8
    s_add_u32 s68, s68, s69
    s_add_u32 s68, s68, 8388608
    s_waitcnt vmcnt(10)
    s_cmp_ge_u32 s2, 16
    s_cbranch_scc1 L_nz2
    s_lshl_b32 s69, s2, 2
    s_add_u32 s69, s69, s66
    s_lshl_b32 s69, s69, 2
    v_mov_b32 v2, s69
    v_mov_b32_e64 v5, 1
    s_mov_b64 exec, 1
    global_store_dword v2, v5, s[30:31] sc1
    s_mov_b64 exec, -1
L_nz2:
    s_nop 0
    ds_read_b64_tr_b16 v[32:33], v20 offset:0
    ds_read_b64_tr_b16 v[34:35], v20 offset:512
    ds_read_b64_tr_b16 v[36:37], v21 offset:0
    ds_read_b64_tr_b16 v[38:39], v21 offset:512
    ds_read_b64_tr_b16 v[40:41], v22 offset:0
    ds_read_b64_tr_b16 v[42:43], v22 offset:512
    ds_read_b64_tr_b16 v[44:45], v23 offset:0
    ds_read_b64_tr_b16 v[46:47], v23 offset:512
    s_waitcnt lgkmcnt(6)
    buffer_store_dwordx4 v[32:35], v24, s[52:55], s68 offen sc1
    s_add_u32 s68, s68, 65536
    s_waitcnt lgkmcnt(4)
    buffer_store_dwordx4 v[36:39], v24, s[52:55], s68 offen sc1
    s_add_u32 s68, s68, 65536
    s_waitcnt lgkmcnt(2)
    buffer_store_dwordx4 v[40:43], v24, s[52:55], s68 offen sc1
    s_add_u32 s68, s68, 65536
    s_waitcnt lgkmcnt(0)
    buffer_store_dwordx4 v[44:47], v24, s[52:55], s68 offen sc1
    s_add_u32 s68, s68, 65536
    s_add_u32 s68, s67, 2
    s_and_b32 s68, s68, 3
    s_add_u32 s68, s68, s81
    s_add_u32 s68, s68, 0
    s_and_b32 s68, s68, 15
    s_lshl_b32 s75, s68, 7
    s_mul_i32 s76, s68, 393216
    s_add_u32 m0, s73, 147456
    s_add_u32 s68, s76, 2048
    buffer_load_dwordx4 v14, s[40:43], s68 offen lds
    s_add_u32 m0, s73, 148480
    s_add_u32 s68, s76, 2048
    buffer_load_dwordx4 v15, s[40:43], s68 offen lds
    s_add_u32 m0, s73, 155648
    s_add_u32 s68, s76, 4096
    buffer_load_dwordx4 v14, s[40:43], s68 offen lds
    s_add_u32 m0, s73, 156672
    s_add_u32 s68, s76, 4096
    buffer_load_dwordx4 v15, s[40:43], s68 offen lds
    s_add_u32 m0, s73, 139264
    s_add_u32 s68, s76, 0
    buffer_load_dwordx4 v14, s[40:43], s68 offen lds
    s_add_u32 m0, s73, 140288
    s_add_u32 s68, s76, 0
    buffer_load_dwordx4 v15, s[40:43], s68 offen lds
    s_waitcnt vmcnt(24)
    s_barrier
    s_add_u32 m0, s77, 122880
    s_nop 0
    buffer_load_dwordx4 v10, s[36:39], s75 offen lds
    s_add_u32 m0, s77, 123904
    s_nop 0
    buffer_load_dwordx4 v11, s[36:39], s75 offen lds
    s_add_u32 m0, s77, 124928
    s_nop 0
    buffer_load_dwordx4 v12, s[36:39], s75 offen lds
    s_add_u32 m0, s77, 125952
    s_nop 0
    buffer_load_dwordx4 v13, s[36:39], s75 offen lds
    s_waitcnt vmcnt(14)
    s_barrier
    s_add_u32 s68, s67, 3
    s_and_b32 s68, s68, 3
    s_add_u32 s68, s68, s81
    s_add_u32 s68, s68, 0
    s_and_b32 s68, s68, 15
    s_lshl_b32 s75, s68, 7
    s_mul_i32 s76, s68, 393216
    s_add_u32 m0, s77, 40960
    s_nop 0
    buffer_load_dwordx4 v10, s[36:39], s75 offen lds
    s_add_u32 m0, s77, 41984
    s_nop 0
    buffer_load_dwordx4 v11, s[36:39], s75 offen lds
    s_add_u32 m0, s77, 43008
    s_nop 0
    buffer_load_dwordx4 v12, s[36:39], s75 offen lds
    s_add_u32 m0, s77, 44032
    s_nop 0
    buffer_load_dwordx4 v13, s[36:39], s75 offen lds
    s_add_u32 m0, s73, 65536
    s_add_u32 s68, s76, 2048
    buffer_load_dwordx4 v14, s[40:43], s68 offen lds
    s_add_u32 m0, s73, 66560
    s_add_u32 s68, s76, 2048
    buffer_load_dwordx4 v15, s[40:43], s68 offen lds
    s_add_u32 m0, s73, 73728
    s_add_u32 s68, s76, 4096
    buffer_load_dwordx4 v14, s[40:43], s68 offen lds
    s_add_u32 m0, s73, 74752
    s_add_u32 s68, s76, 4096
    buffer_load_dwordx4 v15, s[40:43], s68 offen lds
    s_add_u32 m0, s73, 57344
    s_add_u32 s68, s76, 0
    buffer_load_dwordx4 v14, s[40:43], s68 offen lds
    s_add_u32 m0, s73, 58368
    s_add_u32 s68, s76, 0
    buffer_load_dwordx4 v15, s[40:43], s68 offen lds
    s_add_u32 s68, s81, 4
    s_and_b32 s68, s68, 15
    s_mul_i32 s68, s68, 393216
    buffer_load_dword v27, v19, s[40:43], s68 offen
    s_waitcnt vmcnt(11)
    s_barrier
    s_add_u32 s68, s67, 0
    s_and_b32 s68, s68, 1
    s_add_u32 s68, s68, s81
    s_add_u32 s68, s68, 4
    s_and_b32 s68, s68, 15
    s_lshl_b32 s75, s68, 7
    s_mul_i32 s76, s68, 393216
    s_add_u32 m0, s77, 81920
    s_nop 0
    buffer_load_dwordx4 v10, s[36:39], s75 offen lds
    s_add_u32 m0, s77, 82944
    s_nop 0
    buffer_load_dwordx4 v11, s[36:39], s75 offen lds
    s_add_u32 m0, s77, 83968
    s_nop 0
    buffer_load_dwordx4 v12, s[36:39], s75 offen lds
    s_add_u32 m0, s77, 84992
    s_nop 0
    buffer_load_dwordx4 v13, s[36:39], s75 offen lds
    s_add_u32 m0, s73, 106496
    s_add_u32 s68, s76, 2048
    buffer_load_dwordx4 v14, s[40:43], s68 offen lds
    s_add_u32 m0, s73, 107520
    s_add_u32 s68, s76, 2048
    buffer_load_dwordx4 v15, s[40:43], s68 offen lds
    s_add_u32 m0, s73, 114688
    s_add_u32 s68, s76, 4096
    buffer_load_dwordx4 v14, s[40:43], s68 offen lds
    s_add_u32 m0, s73, 115712
    s_add_u32 s68, s76, 4096
    buffer_load_dwordx4 v15, s[40:43], s68 offen lds
    s_add_u32 m0, s73, 98304
    s_add_u32 s68, s76, 0
    buffer_load_dwordx4 v14, s[40:43], s68 offen lds
    s_add_u32 m0, s73, 99328
    s_add_u32 s68, s76, 0
    buffer_load_dwordx4 v15, s[40:43], s68 offen lds
    s_add_u32 s68, s81, 8
    s_and_b32 s68, s68, 15
    s_mul_i32 s68, s68, 393216
    buffer_load_dword v27, v19, s[40:43], s68 offen
    s_waitcnt vmcnt(12)
    s_barrier
    s_add_u32 s68, s67, 1
    s_and_b32 s68, s68, 1
    s_add_u32 s68, s68, s81
    s_add_u32 s68, s68, 4
    s_and_b32 s68, s68, 15
    s_lshl_b32 s75, s68, 7
    s_mul_i32 s76, s68, 393216
    s_add_u32 m0, s77, 122880
    s_nop 0
    buffer_load_dwordx4 v10, s[36:39], s75 offen lds
    s_add_u32 m0, s77, 123904
    s_nop 0
    buffer_load_dwordx4 v11, s[36:39], s75 offen lds
    s_add_u32 m0, s77, 124928
    s_nop 0
    buffer_load_dwordx4 v12, s[36:39], s75 offen lds
    s_add_u32 m0, s77, 125952
    s_nop 0
    buffer_load_dwordx4 v13, s[36:39], s75 offen lds
    s_add_u32 m0, s73, 147456
    s_add_u32 s68, s76, 2048
    buffer_load_dwordx4 v14, s[40:43], s68 offen lds
    s_add_u32 m0, s73, 148480
    s_add_u32 s68, s76, 2048
    buffer_load_dwordx4 v15, s[40:43], s68 offen lds
    s_add_u32 m0, s73, 155648
    s_add_u32 s68, s76, 4096
    buffer_load_dwordx4 v14, s[40:43], s68 offen lds
    s_add_u32 m0, s73, 156672
    s_add_u32 s68, s76, 4096
    buffer_load_dwordx4 v15, s[40:43], s68 offen lds
    s_add_u32 m0, s73, 139264
    s_add_u32 s68, s76, 0
    buffer_load_dwordx4 v14, s[40:43], s68 offen lds
    s_add_u32 m0, s73, 140288
    s_add_u32 s68, s76, 0
    buffer_load_dwordx4 v15, s[40:43], s68 offen lds
    s_waitcnt vmcnt(11)
    s_barrier
    s_add_u32 s68, s67, 0
    s_and_b32 s68, s68, 1
    s_add_u32 s68, s68, s81
    s_add_u32 s68, s68, 6
    s_and_b32 s68, s68, 15
    s_lshl_b32 s75, s68, 7
    s_mul_i32 s76, s68, 393216
    s_add_u32 m0, s77, 40960
    s_nop 0
    buffer_load_dwordx4 v10, s[36:39], s75 offen lds
    s_add_u32 m0, s77, 41984
    s_nop 0
    buffer_load_dwordx4 v11, s[36:39], s75 offen lds
    s_add_u32 m0, s77, 43008
    s_nop 0
    buffer_load_dwordx4 v12, s[36:39], s75 offen lds
    s_add_u32 m0, s77, 44032
    s_nop 0
    buffer_load_dwordx4 v13, s[36:39], s75 offen lds
    s_add_u32 m0, s73, 65536
    s_add_u32 s68, s76, 2048
    buffer_load_dwordx4 v14, s[40:43], s68 offen lds
    s_add_u32 m0, s73, 66560
    s_add_u32 s68, s76, 2048
    buffer_load_dwordx4 v15, s[40:43], s68 offen lds
    s_add_u32 m0, s73, 73728
    s_add_u32 s68, s76, 4096
    buffer_load_dwordx4 v14, s[40:43], s68 offen lds
    s_add_u32 m0, s73, 74752
    s_add_u32 s68, s76, 4096
    buffer_load_dwordx4 v15, s[40:43], s68 offen lds
    s_add_u32 m0, s73, 57344
    s_add_u32 s68, s76, 0
    buffer_load_dwordx4 v14, s[40:43], s68 offen lds
    s_add_u32 m0, s73, 58368
    s_add_u32 s68, s76, 0
    buffer_load_dwordx4 v15, s[40:43], s68 offen lds
    s_waitcnt vmcnt(10)
    s_barrier
    s_add_u32 s68, s67, 1
    s_and_b32 s68, s68, 1
    s_add_u32 s68, s68, s81
    s_add_u32 s68, s68, 6
    s_and_b32 s68, s68, 15
    s_lshl_b32 s75, s68, 7
    s_mul_i32 s76, s68, 393216
    s_add_u32 m0, s77, 81920
    s_nop 0
    buffer_load_dwordx4 v10, s[36:39], s75 offen lds
    s_add_u32 m0, s77, 82944
    s_nop 0
    buffer_load_dwordx4 v11, s[36:39], s75 offen lds
    s_add_u32 m0, s77, 83968
    s_nop 0
    buffer_load_dwordx4 v12, s[36:39], s75 offen lds
    s_add_u32 m0, s77, 84992
    s_nop 0
    buffer_load_dwordx4 v13, s[36:39], s75 offen lds
    s_add_u32 m0, s73, 106496
    s_add_u32 s68, s76, 2048
    buffer_load_dwordx4 v14, s[40:43], s68 offen lds
    s_add_u32 m0, s73, 107520
    s_add_u32 s68, s76, 2048
    buffer_load_dwordx4 v15, s[40:43], s68 offen lds
    s_add_u32 m0, s73, 114688
    s_add_u32 s68, s76, 4096
    buffer_load_dwordx4 v14, s[40:43], s68 offen lds
    s_add_u32 m0, s73, 115712
    s_add_u32 s68, s76, 4096
    buffer_load_dwordx4 v15, s[40:43], s68 offen lds
    s_add_u32 m0, s73, 98304
    s_add_u32 s68, s76, 0
    buffer_load_dwordx4 v14, s[40:43], s68 offen lds
    s_add_u32 m0, s73, 99328
    s_add_u32 s68, s76, 0
    buffer_load_dwordx4 v15, s[40:43], s68 offen lds
    s_waitcnt vmcnt(10)
    s_barrier
    s_add_u32 s68, s67, 0
    s_and_b32 s68, s68, 1
    s_add_u32 s68, s68, s81
    s_add_u32 s68, s68, 8
    s_and_b32 s68, s68, 15
    s_lshl_b32 s75, s68, 7
    s_mul_i32 s76, s68, 393216
    s_add_u32 m0, s77, 122880
    s_nop 0
    buffer_load_dwordx4 v10, s[36:39], s75 offen lds
    v_and_b32 v5, 15, v0
    v_lshrrev_b32_e64 v6, 4, v0
    s_add_u32 m0, s77, 123904
    s_nop 0
    buffer_load_dwordx4 v11, s[36:39], s75 offen lds
    v_and_b32 v30, 1, v0
    v_add_u32_e64 v31, v5, v30
    s_add_u32 m0, s77, 124928
    s_nop 0
    buffer_load_dwordx4 v12, s[36:39], s75 offen lds
    v_lshlrev_b32 v31, 1, v31
    v_lshlrev_b32_e64 v2, 4, v6
    s_add_u32 m0, s77, 125952
    s_nop 0
    buffer_load_dwordx4 v13, s[36:39], s75 offen lds
    v_sub_u32 v31, v2, v31
    v_xor_b32_e64 v30, 1, v30
    s_add_u32 m0, s73, 147456
    s_add_u32 s68, s76, 2048
    buffer_load_dwordx4 v14, s[40:43], s68 offen lds
    v_mul_u32_u24 v30, 2240, v30
    v_add_u32_e64 v31, v31, v30
    s_add_u32 m0, s73, 148480
    s_add_u32 s68, s76, 2048
    buffer_load_dwordx4 v15, s[40:43], s68 offen lds
    s_add_u32 s72, s80, 1568
    v_add_u32_e64 v216, s72, v31
    s_add_u32 m0, s73, 155648
    s_add_u32 s68, s76, 4096
    buffer_load_dwordx4 v14, s[40:43], s68 offen lds
    v_subrev_u32 v217, 1024, v216
    v_subrev_u32 v218, 1536, v216
    s_add_u32 m0, s73, 156672
    s_add_u32 s68, s76, 4096
    buffer_load_dwordx4 v15, s[40:43], s68 offen lds
    v_lshlrev_b32 v30, 2, v5
    v_sub_u32 v30, v2, v30
    s_add_u32 m0, s73, 139264
    s_add_u32 s68, s76, 0
    buffer_load_dwordx4 v14, s[40:43], s68 offen lds
    s_add_u32 s72, s80, 4476
    v_add_u32 v228, s72, v30
    s_add_u32 m0, s73, 140288
    s_add_u32 s68, s76, 0
    buffer_load_dwordx4 v15, s[40:43], s68 offen lds
    v_lshlrev_b32_e64 v2, 3, v6
    s_mov_b32 s8, 0x3f800000
    global_load_dword v28, v1, s[30:31] sc1
    s_add_u32 s68, s81, 12
    s_and_b32 s68, s68, 15
    s_mul_i32 s68, s68, 393216
    buffer_load_dword v27, v19, s[40:43], s68 offen
    s_waitcnt vmcnt(12)
    s_barrier
    s_add_u32 s68, s67, 1
    s_and_b32 s68, s68, 1
    s_add_u32 s68, s68, s81
    s_add_u32 s68, s68, 8
    s_and_b32 s68, s68, 15
    s_lshl_b32 s75, s68, 7
    s_mul_i32 s76, s68, 393216
    s_add_u32 m0, s77, 40960
    s_nop 0
    buffer_load_dwordx4 v10, s[36:39], s75 offen lds
    v_mov_b32 v30, 4064
    v_lshlrev_b32 v30, v5, v30
    s_add_u32 m0, s77, 41984
    s_nop 0
    buffer_load_dwordx4 v11, s[36:39], s75 offen lds
    v_lshrrev_b32 v30, v2, v30
    v_bfe_i32 v31, v30, 0, 1
    s_add_u32 m0, s77, 43008
    s_nop 0
    buffer_load_dwordx4 v12, s[36:39], s75 offen lds
    v_bfe_i32 v29, v30, 1, 1
    v_and_b32 v31, 0x3f80, v31
    s_add_u32 m0, s77, 44032
    s_nop 0
    buffer_load_dwordx4 v13, s[36:39], s75 offen lds
    v_and_or_b32 v232, v29, s8, v31
    v_bfe_i32 v31, v30, 2, 1
    s_add_u32 m0, s73, 65536
    s_add_u32 s68, s76, 2048
    buffer_load_dwordx4 v14, s[40:43], s68 offen lds
    v_bfe_i32 v29, v30, 3, 1
    v_and_b32 v31, 0x3f80, v31
    s_add_u32 m0, s73, 66560
    s_add_u32 s68, s76, 2048
    buffer_load_dwordx4 v15, s[40:43], s68 offen lds
    v_and_or_b32 v233, v29, s8, v31
    v_bfe_i32 v31, v30, 4, 1
    s_add_u32 m0, s73, 73728
    s_add_u32 s68, s76, 4096
    buffer_load_dwordx4 v14, s[40:43], s68 offen lds
    v_bfe_i32 v29, v30, 5, 1
    v_and_b32 v31, 0x3f80, v31
    s_add_u32 m0, s73, 74752
    s_add_u32 s68, s76, 4096
    buffer_load_dwordx4 v15, s[40:43], s68 offen lds
    v_and_or_b32 v234, v29, s8, v31
    v_bfe_i32 v31, v30, 6, 1
    s_add_u32 m0, s73, 57344
    s_add_u32 s68, s76, 0
    buffer_load_dwordx4 v14, s[40:43], s68 offen lds
    v_bfe_i32 v29, v30, 7, 1
    v_and_b32 v31, 0x3f80, v31
    s_add_u32 m0, s73, 58368
    s_add_u32 s68, s76, 0
    buffer_load_dwordx4 v15, s[40:43], s68 offen lds
    v_and_or_b32 v235, v29, s8, v31
    v_mov_b32 v30, 8176
    s_waitcnt vmcnt(11)
    s_barrier
    s_cmp_lg_u32 s66, 0
    s_cbranch_scc1 L_w0b
    s_mov_b32 s69, 400000
L_clr:
    v_cmp_ne_u32_e64 vcc, 0, v28
    s_cmp_eq_u64 vcc, -1
    s_cbranch_scc1 L_clrd
    global_load_dword v28, v1, s[30:31] sc1
    s_waitcnt vmcnt(0)
    s_sub_u32 s69, s69, 1
    s_cmp_lg_u32 s69, 0
    s_cbranch_scc1 L_clr
L_clrd:
    s_mov_b32 s3, 1
    s_atomic_add s3, s[32:33], s74
L_w0b:
    s_add_u32 s68, s67, 0
    s_and_b32 s68, s68, 1
    s_add_u32 s68, s68, s81
    s_add_u32 s68, s68, 10
    s_and_b32 s68, s68, 15
    s_lshl_b32 s75, s68, 7
    s_mul_i32 s76, s68, 393216
    s_add_u32 m0, s77, 81920
    s_nop 0
    buffer_load_dwordx4 v10, s[36:39], s75 offen lds
    v_lshlrev_b32 v30, v5, v30
    v_lshrrev_b32 v30, v2, v30
    s_add_u32 m0, s77, 82944
    s_nop 0
    buffer_load_dwordx4 v11, s[36:39], s75 offen lds
    v_bfe_i32 v31, v30, 0, 1
    v_bfe_i32 v29, v30, 1, 1
    s_add_u32 m0, s77, 83968
    s_nop 0
    buffer_load_dwordx4 v12, s[36:39], s75 offen lds
    v_and_b32 v31, 0x3f80, v31
    v_and_or_b32 v236, v29, s8, v31
    s_add_u32 m0, s77, 84992
    s_nop 0
    s_nop 0
    buffer_load_dwordx4 v13, s[36:39], s75 offen lds
    v_bfe_i32 v31, v30, 2, 1
    v_bfe_i32 v29, v30, 3, 1
    s_add_u32 m0, s73, 106496
    s_add_u32 s68, s76, 2048
    buffer_load_dwordx4 v14, s[40:43], s68 offen lds
    v_and_b32 v31, 0x3f80, v31
    v_and_or_b32 v237, v29, s8, v31
    s_add_u32 m0, s73, 107520
    s_add_u32 s68, s76, 2048
    buffer_load_dwordx4 v15, s[40:43], s68 offen lds
    v_bfe_i32 v31, v30, 4, 1
    v_bfe_i32 v29, v30, 5, 1
    s_add_u32 m0, s73, 114688
    s_add_u32 s68, s76, 4096
    buffer_load_dwordx4 v14, s[40:43], s68 offen lds
    v_and_b32 v31, 0x3f80, v31
    v_and_or_b32 v238, v29, s8, v31
    s_add_u32 m0, s73, 115712
    s_add_u32 s68, s76, 4096
    buffer_load_dwordx4 v15, s[40:43], s68 offen lds
    v_bfe_i32 v31, v30, 6, 1
    v_bfe_i32 v29, v30, 7, 1
    s_add_u32 m0, s73, 98304
    s_add_u32 s68, s76, 0
    buffer_load_dwordx4 v14, s[40:43], s68 offen lds
    v_and_b32 v31, 0x3f80, v31
    v_and_or_b32 v239, v29, s8, v31
    s_add_u32 m0, s73, 99328
    s_add_u32 s68, s76, 0
    buffer_load_dwordx4 v15, s[40:43], s68 offen lds
    v_lshl_add_u32 v5, v5, 1, v6
    v_lshlrev_b32_e64 v2, 6, v5
    s_waitcnt vmcnt(10)
    s_barrier
    s_add_u32 s68, s67, 1
    s_and_b32 s68, s68, 1
    s_add_u32 s68, s68, s81
    s_add_u32 s68, s68, 10
    s_and_b32 s68, s68, 15
    s_lshl_b32 s75, s68, 7
    s_mul_i32 s76, s68, 393216
    s_add_u32 m0, s77, 122880
    s_nop 0
    buffer_load_dwordx4 v10, s[36:39], s75 offen lds
    v_add_u32 v220, 83840, v2
    v_add_u32 v30, 2, v5
    s_add_u32 m0, s77, 123904
    s_nop 0
    buffer_load_dwordx4 v11, s[36:39], s75 offen lds
    v_lshrrev_b32_e64 v30, 2, v30
    s_add_u32 s72, s66, 3
    s_add_u32 m0, s77, 124928
    s_nop 0
    buffer_load_dwordx4 v12, s[36:39], s75 offen lds
    v_add_lshl_u32 v221, v30, s72, 4
    v_and_or_b32 v219, v221, 48, v220
    s_add_u32 m0, s77, 125952
    s_nop 0
    buffer_load_dwordx4 v13, s[36:39], s75 offen lds
    v_add_u32 v30, 1, v5
    v_lshrrev_b32 v30, 2, v30
    s_add_u32 m0, s73, 147456
    s_add_u32 s68, s76, 2048
    buffer_load_dwordx4 v14, s[40:43], s68 offen lds
    v_add_lshl_u32 v30, v30, s72, 4
    v_subrev_u32_e64 v31, 64, v220
    s_add_u32 m0, s73, 148480
    s_add_u32 s68, s76, 2048
    buffer_load_dwordx4 v15, s[40:43], s68 offen lds
    v_and_or_b32 v227, v30, 48, v31
    v_bfe_u32 v5, v0, 2, 3
    s_add_u32 m0, s73, 155648
    s_add_u32 s68, s76, 4096
    buffer_load_dwordx4 v14, s[40:43], s68 offen lds
    v_lshlrev_b32 v5, 13, v5
    v_lshrrev_b32 v6, 5, v0
    s_add_u32 m0, s73, 156672
    s_add_u32 s68, s76, 4096
    buffer_load_dwordx4 v15, s[40:43], s68 offen lds
    v_lshl_add_u32 v5, v6, 12, v5
    v_and_b32_e64 v6, 3, v0
    s_add_u32 m0, s73, 139264
    s_add_u32 s68, s76, 0
    buffer_load_dwordx4 v14, s[40:43], s68 offen lds
    s_bfe_u32 s72, s65, 0x20001
    v_xor_b32 v6, s72, v6
    s_add_u32 m0, s73, 140288
    s_add_u32 s68, s76, 0
    buffer_load_dwordx4 v15, s[40:43], s68 offen lds
    v_lshl_add_u32 v222, v6, 4, v5
    s_lshl_b32 s72, s66, 2
    s_waitcnt vmcnt(10)
    s_barrier
    s_add_u32 s68, s67, 0
    s_and_b32 s68, s68, 1
    s_add_u32 s68, s68, s81
    s_add_u32 s68, s68, 12
    s_and_b32 s68, s68, 15
    s_lshl_b32 s75, s68, 7
    s_mul_i32 s76, s68, 393216
    s_add_u32 m0, s77, 40960
    s_nop 0
    buffer_load_dwordx4 v10, s[36:39], s75 offen lds
    v_mov_b32 v224, s72
    v_mov_b32_e64 v225, 1
    s_add_u32 m0, s77, 41984
    s_nop 0
    buffer_load_dwordx4 v11, s[36:39], s75 offen lds
    v_mov_b32 v226, 0x7000000
    v_lshlrev_b32 v18, 4, v0
    s_add_u32 m0, s77, 43008
    s_nop 0
    buffer_load_dwordx4 v12, s[36:39], s75 offen lds
    v_mov_b32 v32, 0
    v_mov_b32_e64 v33, 0
    s_add_u32 m0, s77, 44032
    s_nop 0
    buffer_load_dwordx4 v13, s[36:39], s75 offen lds
    v_mov_b32 v34, 0
    v_mov_b32_e64 v35, 0
    s_add_u32 m0, s73, 65536
    s_add_u32 s68, s76, 2048
    buffer_load_dwordx4 v14, s[40:43], s68 offen lds
    v_mov_b32 v36, 0
    v_mov_b32 v37, 0
    s_add_u32 m0, s73, 66560
    s_add_u32 s68, s76, 2048
    buffer_load_dwordx4 v15, s[40:43], s68 offen lds
    v_mov_b32 v38, 0
    v_mov_b32 v39, 0
    s_add_u32 m0, s73, 73728
    s_add_u32 s68, s76, 4096
    buffer_load_dwordx4 v14, s[40:43], s68 offen lds
    v_mov_b32 v40, 0
    v_mov_b32 v41, 0
    s_add_u32 m0, s73, 74752
    s_add_u32 s68, s76, 4096
    buffer_load_dwordx4 v15, s[40:43], s68 offen lds
    v_mov_b32 v42, 0
    v_mov_b32 v43, 0
    s_add_u32 m0, s73, 57344
    s_add_u32 s68, s76, 0
    buffer_load_dwordx4 v14, s[40:43], s68 offen lds
    v_mov_b32 v44, 0
    v_mov_b32_e64 v45, 0
    s_add_u32 m0, s73, 58368
    s_add_u32 s68, s76, 0
    buffer_load_dwordx4 v15, s[40:43], s68 offen lds
    v_mov_b32 v46, 0
    v_mov_b32_e64 v47, 0
    s_waitcnt vmcnt(10)
    s_barrier
    s_add_u32 s68, s67, 1
    s_and_b32 s68, s68, 1
    s_add_u32 s68, s68, s81
    s_add_u32 s68, s68, 12
    s_and_b32 s68, s68, 15
    s_lshl_b32 s75, s68, 7
    s_mul_i32 s76, s68, 393216
    s_add_u32 m0, s77, 81920
    s_nop 0
    buffer_load_dwordx4 v10, s[36:39], s75 offen lds
    s_add_u32 m0, s77, 82944
    s_nop 0
    buffer_load_dwordx4 v11, s[36:39], s75 offen lds
    s_add_u32 m0, s77, 83968
    s_nop 0
    buffer_load_dwordx4 v12, s[36:39], s75 offen lds
    s_add_u32 m0, s77, 84992
    s_nop 0
    buffer_load_dwordx4 v13, s[36:39], s75 offen lds
    s_add_u32 m0, s73, 106496
    s_add_u32 s68, s76, 2048
    buffer_load_dwordx4 v14, s[40:43], s68 offen lds
    s_add_u32 m0, s73, 107520
    s_add_u32 s68, s76, 2048
    buffer_load_dwordx4 v15, s[40:43], s68 offen lds
    s_add_u32 m0, s73, 114688
    s_add_u32 s68, s76, 4096
    buffer_load_dwordx4 v14, s[40:43], s68 offen lds
    s_add_u32 m0, s73, 115712
    s_add_u32 s68, s76, 4096
    buffer_load_dwordx4 v15, s[40:43], s68 offen lds
    s_add_u32 m0, s73, 98304
    s_add_u32 s68, s76, 0
    buffer_load_dwordx4 v14, s[40:43], s68 offen lds
    s_add_u32 m0, s73, 99328
    s_add_u32 s68, s76, 0
    buffer_load_dwordx4 v15, s[40:43], s68 offen lds
    s_waitcnt vmcnt(10)
    s_barrier
    s_cmp_lg_u32 s66, 0
    s_cbranch_scc1 L_w0c
    s_waitcnt lgkmcnt(0)
    s_load_dword s4, s[32:33], s74 glc
L_w0c:
    s_add_u32 s68, s67, 0
    s_and_b32 s68, s68, 1
    s_add_u32 s68, s68, s81
    s_add_u32 s68, s68, 14
    s_and_b32 s68, s68, 15
    s_lshl_b32 s75, s68, 7
    s_mul_i32 s76, s68, 393216
    s_add_u32 m0, s77, 122880
    s_nop 0
    buffer_load_dwordx4 v10, s[36:39], s75 offen lds
    s_add_u32 m0, s77, 123904
    s_nop 0
    buffer_load_dwordx4 v11, s[36:39], s75 offen lds
    s_add_u32 m0, s77, 124928
    s_nop 0
    buffer_load_dwordx4 v12, s[36:39], s75 offen lds
    s_add_u32 m0, s77, 125952
    s_nop 0
    s_nop 0
    buffer_load_dwordx4 v13, s[36:39], s75 offen lds
    s_add_u32 m0, s73, 147456
    s_add_u32 s68, s76, 2048
    buffer_load_dwordx4 v14, s[40:43], s68 offen lds
    s_add_u32 m0, s73, 148480
    s_add_u32 s68, s76, 2048
    buffer_load_dwordx4 v15, s[40:43], s68 offen lds
    s_add_u32 m0, s73, 155648
    s_add_u32 s68, s76, 4096
    buffer_load_dwordx4 v14, s[40:43], s68 offen lds
    s_add_u32 m0, s73, 156672
    s_add_u32 s68, s76, 4096
    buffer_load_dwordx4 v15, s[40:43], s68 offen lds
    s_add_u32 m0, s73, 139264
    s_add_u32 s68, s76, 0
    buffer_load_dwordx4 v14, s[40:43], s68 offen lds
    s_add_u32 m0, s73, 140288
    s_add_u32 s68, s76, 0
    buffer_load_dwordx4 v15, s[40:43], s68 offen lds
    s_and_b32 s68, s61, 15
    s_lshl_b32 s68, s68, 2
    s_add_u32 s68, s68, s66
    s_lshl_b32 s68, s68, 15
    s_lshr_b32 s69, s61, 4
    s_lshl_b32 s69, s69, 10
    s_add_u32 s68, s68, s69
    v_lshrrev_b32 v19, 4, v0
    v_lshlrev_b32_e64 v19, 26, v19
    v_lshl_add_u32 v19, v0, 11, v19
    buffer_load_dword v25, v19, s[44:47], s68 offen offset:384
    s_waitcnt vmcnt(11)
    s_barrier
    s_add_u32 s68, s67, 1
    s_and_b32 s68, s68, 1
    s_add_u32 s68, s68, s81
    s_add_u32 s68, s68, 14
    s_and_b32 s68, s68, 15
    s_lshl_b32 s75, s68, 7
    s_mul_i32 s76, s68, 393216
    s_add_u32 m0, s77, 40960
    s_nop 0
    buffer_load_dwordx4 v10, s[36:39], s75 offen lds
    s_add_u32 m0, s77, 41984
    s_nop 0
    buffer_load_dwordx4 v11, s[36:39], s75 offen lds
    s_add_u32 m0, s77, 43008
    s_nop 0
    buffer_load_dwordx4 v12, s[36:39], s75 offen lds
    s_add_u32 m0, s77, 44032
    s_nop 0
    buffer_load_dwordx4 v13, s[36:39], s75 offen lds
    s_add_u32 m0, s73, 65536
    s_add_u32 s68, s76, 2048
    buffer_load_dwordx4 v14, s[40:43], s68 offen lds
    s_add_u32 m0, s73, 66560
    s_add_u32 s68, s76, 2048
    buffer_load_dwordx4 v15, s[40:43], s68 offen lds
    s_add_u32 m0, s73, 73728
    s_add_u32 s68, s76, 4096
    buffer_load_dwordx4 v14, s[40:43], s68 offen lds
    s_add_u32 m0, s73, 74752
    s_add_u32 s68, s76, 4096
    buffer_load_dwordx4 v15, s[40:43], s68 offen lds
    s_add_u32 m0, s73, 57344
    s_add_u32 s68, s76, 0
    buffer_load_dwordx4 v14, s[40:43], s68 offen lds
    s_add_u32 m0, s73, 58368
    s_add_u32 s68, s76, 0
    buffer_load_dwordx4 v15, s[40:43], s68 offen lds
    s_add_u32 m0, s70, 20480
    s_and_b32 s71, s71, 0x1fffff
    buffer_load_dwordx4 v17, s[44:47], s71 offen lds
    s_add_u32 s71, s71, 65536
    s_add_u32 m0, s70, 24576
    s_and_b32 s71, s71, 0x1fffff
    buffer_load_dwordx4 v17, s[44:47], s71 offen lds
    s_add_u32 s71, s71, 65536
    s_cmp_lg_u32 s66, 0
    s_cbranch_scc1 L_uwd
    s_mov_b32 s69, 400000
L_uw:
    s_waitcnt lgkmcnt(0)
    s_cmp_eq_u32 s4, 16
    s_cbranch_scc1 L_uwd
    s_load_dword s4, s[32:33], s74 glc
    s_sub_u32 s69, s69, 1
    s_cmp_lg_u32 s69, 0
    s_cbranch_scc1 L_uw
    s_waitcnt lgkmcnt(0)
L_uwd:
    s_waitcnt vmcnt(13)
    s_barrier
    s_lshl_b32 s68, s101, 12
    s_add_u32 s68, s68, 8388608
    s_mov_b32 m0, s79
    s_nop 0
    buffer_load_dwordx4 v18, s[52:55], s68 offen offset:0 sc1 lds
    buffer_load_dwordx4 v18, s[52:55], s68 offen offset:1024 sc1 lds
    buffer_load_dwordx4 v18, s[52:55], s68 offen offset:2048 sc1 lds
    buffer_load_dwordx4 v18, s[52:55], s68 offen offset:3072 sc1 lds
    s_and_b32 s69, s66, 1
    s_lshl_b32 s69, s69, 10
    s_add_u32 m0, s69, 81920
    s_nop 0
    s_nop 0
    buffer_load_dwordx4 v226, s[52:55], 0 offen lds
    s_add_u32 m0, s70, 28672
    s_and_b32 s71, s71, 0x1fffff
    buffer_load_dwordx4 v17, s[44:47], s71 offen lds
    s_add_u32 s71, s71, 65536
    s_add_u32 m0, s70, 32768
    s_and_b32 s71, s71, 0x1fffff
    buffer_load_dwordx4 v17, s[44:47], s71 offen lds
    s_add_u32 s71, s71, 65536
    s_add_u32 m0, s70, 106496
    s_and_b32 s71, s71, 0x1fffff
    buffer_load_dwordx4 v17, s[44:47], s71 offen lds
    s_add_u32 s71, s71, 65536
    s_add_u32 m0, s70, 110592
    s_and_b32 s71, s71, 0x1fffff
    buffer_load_dwordx4 v17, s[44:47], s71 offen lds
    s_add_u32 s71, s71, 65536
    s_waitcnt vmcnt(11)
    s_barrier
    s_add_u32 m0, s70, 114688
    s_and_b32 s71, s71, 0x1fffff
    buffer_load_dwordx4 v17, s[44:47], s71 offen lds
    s_add_u32 s71, s71, 65536
    s_add_u32 m0, s70, 118784
    s_and_b32 s71, s71, 0x1fffff
    buffer_load_dwordx4 v17, s[44:47], s71 offen lds
    s_add_u32 s71, s71, 65536
    s_add_u32 m0, s70, 122880
    s_and_b32 s71, s71, 0x1fffff
    buffer_load_dwordx4 v17, s[44:47], s71 offen lds
    s_add_u32 s71, s71, 65536
    s_add_u32 m0, s70, 126976
    s_and_b32 s71, s71, 0x1fffff
    buffer_load_dwordx4 v17, s[44:47], s71 offen lds
    s_add_u32 s71, s71, 65536
    s_add_u32 m0, s70, 131072
    s_and_b32 s71, s71, 0x1fffff
    buffer_load_dwordx4 v17, s[44:47], s71 offen lds
    s_add_u32 s71, s71, 65536
    s_add_u32 m0, s70, 135168
    s_and_b32 s71, s71, 0x1fffff
    buffer_load_dwordx4 v17, s[44:47], s71 offen lds
    s_add_u32 s71, s71, 65536
    s_add_u32 m0, s70, 139264
    s_and_b32 s71, s71, 0x1fffff
    buffer_load_dwordx4 v17, s[44:47], s71 offen lds
    s_add_u32 s71, s71, 65536
    s_add_u32 m0, s70, 143360
    s_and_b32 s71, s71, 0x1fffff
    buffer_load_dwordx4 v17, s[44:47], s71 offen lds
    s_add_u32 s71, s71, 65536
    s_add_u32 m0, s70, 147456
    s_and_b32 s71, s71, 0x1fffff
    buffer_load_dwordx4 v17, s[44:47], s71 offen lds
    s_add_u32 s71, s71, 65536
    s_add_u32 m0, s70, 151552
    s_and_b32 s71, s71, 0x1fffff
    buffer_load_dwordx4 v17, s[44:47], s71 offen lds
    s_add_u32 s71, s71, 65536
    s_add_u32 m0, s70, 155648
    s_and_b32 s71, s71, 0x1fffff
    buffer_load_dwordx4 v17, s[44:47], s71 offen lds
    s_add_u32 s71, s71, 65536
    s_add_u32 m0, s70, 159744
    s_and_b32 s71, s71, 0x1fffff
    buffer_load_dwordx4 v17, s[44:47], s71 offen lds
    s_add_u32 s71, s71, 65536
    buffer_load_dwordx4 v[160:163], v17, s[44:47], s6 offen
    s_add_u32 s6, s6, 16384
    buffer_load_dwordx4 v[164:167], v17, s[44:47], s6 offen
    s_add_u32 s6, s6, 16384
    buffer_load_dwordx4 v[168:171], v17, s[44:47], s6 offen
    s_add_u32 s6, s6, 16384
    buffer_load_dwordx4 v[172:175], v17, s[44:47], s6 offen
    s_add_u32 s6, s6, 16384
    s_and_b32 s5, s5, 0x1fffff
    buffer_load_dwordx4 v[176:179], v17, s[44:47], s5 offen
    s_add_u32 s5, s5, 65536
    s_and_b32 s5, s5, 0x1fffff
    buffer_load_dwordx4 v[180:183], v17, s[44:47], s5 offen
    s_add_u32 s5, s5, 65536
    s_and_b32 s5, s5, 0x1fffff
    buffer_load_dwordx4 v[184:187], v17, s[44:47], s5 offen
    s_add_u32 s5, s5, 65536
    s_and_b32 s5, s5, 0x1fffff
    buffer_load_dwordx4 v[188:191], v17, s[44:47], s5 offen
    s_add_u32 s5, s5, 65536
    s_and_b32 s5, s5, 0x1fffff
    buffer_load_dwordx4 v[192:195], v17, s[44:47], s5 offen
    s_add_u32 s5, s5, 65536
    s_and_b32 s5, s5, 0x1fffff
    buffer_load_dwordx4 v[196:199], v17, s[44:47], s5 offen
    s_add_u32 s5, s5, 65536
    s_and_b32 s5, s5, 0x1fffff
    buffer_load_dwordx4 v[200:203], v17, s[44:47], s5 offen
    s_add_u32 s5, s5, 65536
    s_and_b32 s5, s5, 0x1fffff
    buffer_load_dwordx4 v[204:207], v17, s[44:47], s5 offen
    s_add_u32 s5, s5, 65536
    s_and_b32 s5, s5, 0x1fffff
    buffer_load_dwordx4 v[208:211], v17, s[44:47], s5 offen
    s_add_u32 s5, s5, 65536
    s_and_b32 s5, s5, 0x1fffff
    buffer_load_dwordx4 v[212:215], v17, s[44:47], s5 offen
    s_add_u32 s5, s5, 65536
    v_add_u32_e64 v26, s70, v18
    v_add_u32 v26, 40960, v26
    v_add_u32 v27, s80, v18
    s_waitcnt vmcnt(30)
    ds_write_b32 v224, v225 offset:96
    s_mov_b32 s69, 3200000
lpoll_25:
    ds_read_b32 v9, v7 offset:0
    s_waitcnt lgkmcnt(0)
    v_cmp_ne_u32 vcc, 0, v9
    s_cmp_eq_u64 vcc, -1
    s_cbranch_scc1 lpolld_26
    s_sleep 2
    s_sub_u32 s69, s69, 1
    s_cmp_lg_u32 s69, 0
    s_cbranch_scc1 lpoll_25
lpolld_26:
    ds_read2_b32 v[28:29], v218 offset0:0 offset1:1
    ds_read2_b32 v[30:31], v218 offset0:2 offset1:3
    ds_read2_b32 v[240:241], v228 offset0:48 offset1:49
    ds_read2_b32 v[242:243], v228 offset0:50 offset1:51
    ds_read2_b32 v[244:245], v228 offset0:32 offset1:33
    ds_read2_b32 v[246:247], v228 offset0:34 offset1:35
    ds_read2_b32 v[248:249], v228 offset0:16 offset1:17
    ds_read2_b32 v[250:251], v228 offset0:18 offset1:19
    ds_read2_b32 v[252:253], v228 offset0:0 offset1:1
    ds_read2_b32 v[254:255], v228 offset0:2 offset1:3
    s_mov_b32 s69, 3200000
lpoll_27:
    ds_read_b32 v9, v7 offset:96
    s_waitcnt lgkmcnt(0)
    v_cmp_ne_u32_e64 vcc, 0, v9
    s_cmp_eq_u64 vcc, -1
    s_cbranch_scc1 lpolld_28
    s_sub_u32 s69, s69, 1
    s_cmp_lg_u32 s69, 0
    s_cbranch_scc1 lpoll_27
lpolld_28:
    ds_read_b128 v[96:99], v219 offset:0
    ds_read_b128 v[80:83], v227 offset:0
    ds_read_b128 v[100:103], v219 offset:2048
    ds_read_b128 v[84:87], v227 offset:2048
    ds_read_b128 v[104:107], v219 offset:4096
    ds_read_b128 v[88:91], v227 offset:4096
    ds_read_b128 v[108:111], v219 offset:6144
    ds_read_b128 v[92:95], v227 offset:6144
    ds_read_b128 v[112:115], v219 offset:8192
    ds_read_b128 v[116:119], v219 offset:10240
    ds_read_b128 v[120:123], v219 offset:12288
    ds_read_b128 v[124:127], v219 offset:14336
    s_mov_b32 s72, 0
    s_setprio 1
    s_waitcnt lgkmcnt(10)
    v_mfma_f32_16x16x32_bf16 v[128:131], v[96:99], v[232:235], 0
    ds_read2_b32 v[76:77], v217 offset0:0 offset1:1
    v_mfma_f32_16x16x32_bf16 v[144:147], v[80:83], v[236:239], 0
    ds_read2_b32 v[78:79], v217 offset0:2 offset1:3
    s_waitcnt lgkmcnt(10)
    v_mfma_f32_16x16x32_bf16 v[132:135], v[100:103], v[232:235], 0
    ds_read2_b32 v[72:73], v217 offset0:128 offset1:129
    v_mfma_f32_16x16x32_bf16 v[148:151], v[84:87], v[236:239], 0
    ds_read2_b32 v[74:75], v217 offset0:130 offset1:131
    s_waitcnt lgkmcnt(10)
    v_mfma_f32_16x16x32_bf16 v[136:139], v[104:107], v[232:235], 0
    ds_read2_b32 v[68:69], v216 offset0:0 offset1:1
    v_mfma_f32_16x16x32_bf16 v[152:155], v[88:91], v[236:239], 0
    ds_read2_b32 v[70:71], v216 offset0:2 offset1:3
    s_waitcnt lgkmcnt(10)
    v_mfma_f32_16x16x32_bf16 v[140:143], v[108:111], v[232:235], 0
    ds_read2_b32 v[64:65], v216 offset0:128 offset1:129
    v_mfma_f32_16x16x32_bf16 v[156:159], v[92:95], v[236:239], 0
    ds_read2_b32 v[66:67], v216 offset0:130 offset1:131
    v_mfma_f32_16x16x32_bf16 v[48:51], v[28:31], v[96:99], 0
    v_cvt_pk_bf16_f32 v128, v128, v144
    v_cvt_pk_bf16_f32 v129, v129, v145
    v_mfma_f32_16x16x32_bf16 v[52:55], v[28:31], v[100:103], 0
    v_cvt_pk_bf16_f32 v130, v130, v146
    v_cvt_pk_bf16_f32 v131, v131, v147
    v_mfma_f32_16x16x32_bf16 v[56:59], v[28:31], v[104:107], 0
    v_cvt_pk_bf16_f32 v132, v132, v148
    v_cvt_pk_bf16_f32 v133, v133, v149
    v_mfma_f32_16x16x32_bf16 v[60:63], v[28:31], v[108:111], 0
    v_cvt_pk_bf16_f32 v134, v134, v150
    v_cvt_pk_bf16_f32 v135, v135, v151
    v_mfma_f32_16x16x32_bf16 v[48:51], v[128:131], v[240:243], v[48:51]
    v_cvt_pk_bf16_f32 v136, v136, v152
    v_cvt_pk_bf16_f32 v137, v137, v153
    v_mfma_f32_16x16x32_bf16 v[52:55], v[128:131], v[244:247], v[52:55]
    v_cvt_pk_bf16_f32 v138, v138, v154
    v_cvt_pk_bf16_f32 v139, v139, v155
    v_mfma_f32_16x16x32_bf16 v[56:59], v[128:131], v[248:251], v[56:59]
    v_cvt_pk_bf16_f32 v140, v140, v156
    v_cvt_pk_bf16_f32 v141, v141, v157
    v_mfma_f32_16x16x32_bf16 v[60:63], v[128:131], v[252:255], v[60:63]
    v_cvt_pk_bf16_f32 v142, v142, v158
    v_cvt_pk_bf16_f32 v143, v143, v159
    v_mfma_f32_16x16x32_bf16 v[52:55], v[132:135], v[240:243], v[52:55]
    v_mfma_f32_16x16x32_bf16 v[56:59], v[132:135], v[244:247], v[56:59]
    v_mfma_f32_16x16x32_bf16 v[60:63], v[132:135], v[248:251], v[60:63]
    v_mfma_f32_16x16x32_bf16 v[56:59], v[136:139], v[240:243], v[56:59]
    v_mfma_f32_16x16x32_bf16 v[60:63], v[136:139], v[244:247], v[60:63]
    v_mfma_f32_16x16x32_bf16 v[60:63], v[140:143], v[240:243], v[60:63]
    s_waitcnt lgkmcnt(0)
    .p2align 3
L_conv:
    v_mfma_f32_16x16x32_bf16 v[44:47], v[76:79], v[96:99], v[44:47]
    v_subrev_u32 v221, 16, v221
    v_subrev_u32 v217, 64, v217
    v_mfma_f32_16x16x32_bf16 v[48:51], v[76:79], v[100:103], v[48:51]
    v_subrev_u32 v220, 0x100, v220
    v_mfma_f32_16x16x32_bf16 v[52:55], v[76:79], v[104:107], v[52:55]
    v_and_or_b32 v219, v221, 48, v220
    v_mfma_f32_16x16x32_bf16 v[56:59], v[76:79], v[108:111], v[56:59]
    v_subrev_u32 v216, 64, v216
    s_add_u32 s72, s72, 1
    v_mfma_f32_16x16x32_bf16 v[60:63], v[76:79], v[112:115], v[60:63]
    ds_read2_b32 v[92:93], v217 offset0:0 offset1:1
    v_mfma_f32_16x16x32_bf16 v[56:59], v[72:75], v[112:115], v[56:59]
    ds_read2_b32 v[94:95], v217 offset0:2 offset1:3
    v_mfma_f32_16x16x32_bf16 v[60:63], v[72:75], v[116:119], v[60:63]
    ds_read_b128 v[128:131], v219 offset:0
    v_mfma_f32_16x16x32_bf16 v[52:55], v[72:75], v[108:111], v[52:55]
    ds_read_b128 v[132:135], v219 offset:2048
    v_mfma_f32_16x16x32_bf16 v[48:51], v[72:75], v[104:107], v[48:51]
    ds_read_b128 v[136:139], v219 offset:4096
    v_mfma_f32_16x16x32_bf16 v[44:47], v[72:75], v[100:103], v[44:47]
    ds_read_b128 v[140:143], v219 offset:6144
    v_mfma_f32_16x16x32_bf16 v[40:43], v[72:75], v[96:99], v[40:43]
    ds_read_b128 v[144:147], v219 offset:8192
    v_mfma_f32_16x16x32_bf16 v[36:39], v[68:71], v[96:99], v[36:39]
    ds_read2_b32 v[88:89], v217 offset0:128 offset1:129
    v_mfma_f32_16x16x32_bf16 v[40:43], v[68:71], v[100:103], v[40:43]
    ds_read2_b32 v[90:91], v217 offset0:130 offset1:131
    v_mfma_f32_16x16x32_bf16 v[44:47], v[68:71], v[104:107], v[44:47]
    ds_read_b128 v[148:151], v219 offset:10240
    v_mfma_f32_16x16x32_bf16 v[48:51], v[68:71], v[108:111], v[48:51]
    ds_read2_b32 v[84:85], v216 offset0:0 offset1:1
    v_mfma_f32_16x16x32_bf16 v[52:55], v[68:71], v[112:115], v[52:55]
    ds_read2_b32 v[86:87], v216 offset0:2 offset1:3
    v_mfma_f32_16x16x32_bf16 v[56:59], v[68:71], v[116:119], v[56:59]
    ds_read_b128 v[152:155], v219 offset:12288
    v_mfma_f32_16x16x32_bf16 v[60:63], v[68:71], v[120:123], v[60:63]
    ds_read2_b32 v[80:81], v216 offset0:128 offset1:129
    v_mfma_f32_16x16x32_bf16 v[56:59], v[64:67], v[120:123], v[56:59]
    ds_read2_b32 v[82:83], v216 offset0:130 offset1:131
    v_mfma_f32_16x16x32_bf16 v[60:63], v[64:67], v[124:127], v[60:63]
    ds_read_b128 v[156:159], v219 offset:14336
    v_mfma_f32_16x16x32_bf16 v[52:55], v[64:67], v[116:119], v[52:55]
    v_mfma_f32_16x16x32_bf16 v[48:51], v[64:67], v[112:115], v[48:51]
    v_mfma_f32_16x16x32_bf16 v[44:47], v[64:67], v[108:111], v[44:47]
    v_mfma_f32_16x16x32_bf16 v[40:43], v[64:67], v[104:107], v[40:43]
    v_mfma_f32_16x16x32_bf16 v[36:39], v[64:67], v[100:103], v[36:39]
    v_mfma_f32_16x16x32_bf16 v[32:35], v[64:67], v[96:99], v[32:35]
    s_cmp_eq_u32 s72, 7
    s_cbranch_scc0 nops_29
    s_mov_b32 s69, 3200000
lpoll_30:
    ds_read_b32 v9, v224 offset:112
    s_waitcnt lgkmcnt(0)
    v_cmp_ne_u32 vcc, 0, v9
    s_cmp_eq_u64 vcc, -1
    s_cbranch_scc1 lpolld_31
    s_sleep 1
    s_sub_u32 s69, s69, 1
    s_cmp_lg_u32 s69, 0
    s_cbranch_scc1 lpoll_30
lpolld_31:
    .p2align 3
nops_29:
    s_waitcnt lgkmcnt(0)
    s_nop 0
    v_mfma_f32_16x16x32_bf16 v[44:47], v[92:95], v[128:131], v[44:47]
    v_subrev_u32 v221, 16, v221
    v_subrev_u32 v217, 64, v217
    v_mfma_f32_16x16x32_bf16 v[48:51], v[92:95], v[132:135], v[48:51]
    v_subrev_u32 v220, 0x100, v220
    v_mfma_f32_16x16x32_bf16 v[52:55], v[92:95], v[136:139], v[52:55]
    v_and_or_b32 v219, v221, 48, v220
    v_mfma_f32_16x16x32_bf16 v[56:59], v[92:95], v[140:143], v[56:59]
    v_subrev_u32 v216, 64, v216
    s_add_u32 s72, s72, 1
    v_mfma_f32_16x16x32_bf16 v[60:63], v[92:95], v[144:147], v[60:63]
    ds_read2_b32 v[76:77], v217 offset0:0 offset1:1
    v_mfma_f32_16x16x32_bf16 v[56:59], v[88:91], v[144:147], v[56:59]
    ds_read2_b32 v[78:79], v217 offset0:2 offset1:3
    v_mfma_f32_16x16x32_bf16 v[60:63], v[88:91], v[148:151], v[60:63]
    ds_read_b128 v[96:99], v219 offset:0
    v_mfma_f32_16x16x32_bf16 v[52:55], v[88:91], v[140:143], v[52:55]
    ds_read_b128 v[100:103], v219 offset:2048
    v_mfma_f32_16x16x32_bf16 v[48:51], v[88:91], v[136:139], v[48:51]
    ds_read_b128 v[104:107], v219 offset:4096
    v_mfma_f32_16x16x32_bf16 v[44:47], v[88:91], v[132:135], v[44:47]
    ds_read_b128 v[108:111], v219 offset:6144
    v_mfma_f32_16x16x32_bf16 v[40:43], v[88:91], v[128:131], v[40:43]
    ds_read_b128 v[112:115], v219 offset:8192
    v_mfma_f32_16x16x32_bf16 v[36:39], v[84:87], v[128:131], v[36:39]
    ds_read2_b32 v[72:73], v217 offset0:128 offset1:129
    v_mfma_f32_16x16x32_bf16 v[40:43], v[84:87], v[132:135], v[40:43]
    ds_read2_b32 v[74:75], v217 offset0:130 offset1:131
    v_mfma_f32_16x16x32_bf16 v[44:47], v[84:87], v[136:139], v[44:47]
    ds_read_b128 v[116:119], v219 offset:10240
    v_mfma_f32_16x16x32_bf16 v[48:51], v[84:87], v[140:143], v[48:51]
    ds_read2_b32 v[68:69], v216 offset0:0 offset1:1
    v_mfma_f32_16x16x32_bf16 v[52:55], v[84:87], v[144:147], v[52:55]
    ds_read2_b32 v[70:71], v216 offset0:2 offset1:3
    v_mfma_f32_16x16x32_bf16 v[56:59], v[84:87], v[148:151], v[56:59]
    ds_read_b128 v[120:123], v219 offset:12288
    v_mfma_f32_16x16x32_bf16 v[60:63], v[84:87], v[152:155], v[60:63]
    ds_read2_b32 v[64:65], v216 offset0:128 offset1:129
    v_mfma_f32_16x16x32_bf16 v[56:59], v[80:83], v[152:155], v[56:59]
    ds_read2_b32 v[66:67], v216 offset0:130 offset1:131
    v_mfma_f32_16x16x32_bf16 v[60:63], v[80:83], v[156:159], v[60:63]
    ds_read_b128 v[124:127], v219 offset:14336
    v_mfma_f32_16x16x32_bf16 v[52:55], v[80:83], v[148:151], v[52:55]
    v_mfma_f32_16x16x32_bf16 v[48:51], v[80:83], v[144:147], v[48:51]
    v_mfma_f32_16x16x32_bf16 v[44:47], v[80:83], v[140:143], v[44:47]
    v_mfma_f32_16x16x32_bf16 v[40:43], v[80:83], v[136:139], v[40:43]
    v_mfma_f32_16x16x32_bf16 v[36:39], v[80:83], v[132:135], v[36:39]
    s_cmp_lt_u32 s72, 8
    s_nop 0
    v_mfma_f32_16x16x32_bf16 v[32:35], v[80:83], v[128:131], v[32:35]
    s_waitcnt lgkmcnt(0)
    s_cbranch_scc1 L_conv
    s_waitcnt vmcnt(0)
    ds_write_b32 v224, v225 offset:32
    s_lshl_b32 s68, s64, 18
    s_and_b32 s69, s101, 63
    s_lshl_b32 s69, s69, 6
    s_add_u32 s68, s68, s69
    s_add_u32 s68, s68, 12582912
    v_cvt_pk_bf16_f32 v64, v32, v33
    v_cvt_pk_bf16_f32 v65, v34, v35
    v_cvt_pk_bf16_f32 v66, v36, v37
    v_cvt_pk_bf16_f32 v67, v38, v39
    s_nop 0
    v_permlane16_swap_b32 v64, v66
    v_permlane16_swap_b32 v65, v67
    buffer_store_dwordx4 v[64:67], v222, s[52:55], s68 offen sc1
    s_add_u32 s68, s68, 65536
    v_cvt_pk_bf16_f32 v68, v40, v41
    v_cvt_pk_bf16_f32 v69, v42, v43
    v_cvt_pk_bf16_f32 v70, v44, v45
    v_cvt_pk_bf16_f32 v71, v46, v47
    s_nop 0
    v_permlane16_swap_b32 v68, v70
    v_permlane16_swap_b32 v69, v71
    s_nop 0
    buffer_store_dwordx4 v[68:71], v222, s[52:55], s68 offen sc1
    s_add_u32 s68, s68, 65536
    v_cvt_pk_bf16_f32 v72, v48, v49
    v_cvt_pk_bf16_f32 v73, v50, v51
    v_cvt_pk_bf16_f32 v74, v52, v53
    v_cvt_pk_bf16_f32 v75, v54, v55
    s_nop 0
    v_permlane16_swap_b32 v72, v74
    v_permlane16_swap_b32 v73, v75
    s_nop 0
    buffer_store_dwordx4 v[72:75], v222, s[52:55], s68 offen sc1
    s_add_u32 s68, s68, 65536
    v_cvt_pk_bf16_f32 v76, v56, v57
    v_cvt_pk_bf16_f32 v77, v58, v59
    v_cvt_pk_bf16_f32 v78, v60, v61
    v_cvt_pk_bf16_f32 v79, v62, v63
    s_nop 0
    v_permlane16_swap_b32 v76, v78
    v_permlane16_swap_b32 v77, v79
    s_nop 0
    buffer_store_dwordx4 v[76:79], v222, s[52:55], s68 offen sc1
    s_add_u32 s68, s68, 65536
    ds_write_b128 v26, v[176:179] offset:0
    ds_write_b128 v26, v[180:183] offset:4096
    ds_write_b128 v26, v[184:187] offset:8192
    ds_write_b128 v26, v[188:191] offset:12288
    ds_write_b128 v26, v[192:195] offset:16384
    ds_write_b128 v26, v[196:199] offset:20480
    ds_write_b128 v26, v[200:203] offset:24576
    ds_write_b128 v26, v[204:207] offset:28672
    ds_write_b128 v26, v[208:211] offset:32768
    ds_write_b128 v26, v[212:215] offset:36864
    ds_write_b128 v27, v[160:163] offset:0
    ds_write_b128 v27, v[164:167] offset:1024
    ds_write_b128 v27, v[168:171] offset:2048
    ds_write_b128 v27, v[172:175] offset:3072
    ds_write_b32 v224, v225 offset:48
    s_waitcnt vmcnt(0)
    v_mov_b32 v10, 88
    v_mov_b32_e64 v11, 1
    s_mov_b64 exec, 1
    ds_add_rtn_u32 v11, v10, v11
    s_mov_b64 exec, -1
    s_lshl_b32 s68, s64, 11
    s_add_u32 s68, s68, 98304
    s_waitcnt lgkmcnt(0)
    v_readfirstlane_b32 s73, v11
    s_mov_b32 s3, 1
    s_nop 1
    s_cmp_eq_u32 s73, 3
    s_cbranch_scc0 notlast_32
    s_atomic_add s3, s[32:33], s68
notlast_32:
    v_and_b32 v5, 3, v0
    v_lshrrev_b32 v6, 5, v0
    v_lshl_add_u32 v6, v6, 2, v5
    v_lshlrev_b32_e64 v6, 9, v6
    v_bfe_u32 v13, v0, 2, 2
    v_lshl_add_u32 v6, v13, 6, v6
    v_lshl_add_u32 v6, v5, 4, v6
    v_bfe_u32 v12, v0, 4, 1
    v_lshl_add_u32 v6, v12, 3, v6
    v_add_u32 v20, s79, v6
    v_xor_b32 v21, 16, v20
    v_xor_b32 v22, 32, v20
    v_xor_b32 v23, 48, v20
    v_lshrrev_b32_e64 v6, 5, v0
    v_lshl_add_u32 v6, v6, 2, v13
    v_lshlrev_b32 v2, 1, v5
    v_xor_b32 v6, v6, v2
    v_lshl_add_u32 v5, v12, 2, v5
    v_lshlrev_b32_e64 v5, 7, v5
    v_lshl_add_u32 v5, v6, 4, v5
    v_add_u32 v24, s79, v5
    v_add_u32 v25, s79, v18
    v_bfe_u32 v6, v0, 3, 2
    v_lshlrev_b32 v6, 1, v6
    v_xor_b32 v6, v6, v4
    v_lshlrev_b32_e64 v5, 12, v3
    v_lshl_add_u32 v5, v6, 4, v5
    s_cmp_eq_u32 s73, 3
    s_cbranch_scc0 follow_33
    s_mov_b64 exec, 1
    s_lshl_b32 s68, s64, 11
    s_add_u32 s68, s68, 98304
    v_lshlrev_b32_e64 v10, 7, v0
    s_mov_b32 s22, 400000
    s_waitcnt lgkmcnt(0)
gp_34:
    s_load_dword s3, s[32:33], s68 glc
    s_waitcnt lgkmcnt(0)
    s_cmp_eq_u32 s3, 16
    s_cbranch_scc1 gpd_35
    s_sub_u32 s22, s22, 1
    s_cmp_lg_u32 s22, 0
    s_cbranch_scc1 gp_34
gpd_35:
    v_mov_b32 v10, 92
    v_mov_b32 v11, 1
    ds_write_b32 v10, v11
    s_mov_b64 exec, -1
    s_branch gpe_36
follow_33:
    v_mov_b32 v10, 92
    s_mov_b32 s69, 3200000
lpoll_37:
    ds_read_b32 v11, v10 offset:0
    s_waitcnt lgkmcnt(0)
    v_cmp_ne_u32 vcc, 0, v11
    s_cmp_eq_u64 vcc, -1
    s_cbranch_scc1 lpolld_38
    s_sleep 1
    s_sub_u32 s69, s69, 1
    s_cmp_lg_u32 s69, 0
    s_cbranch_scc1 lpoll_37
lpolld_38:
gpe_36:
    s_mov_b32 s69, 3200000
lpoll_39:
    ds_read_b32 v9, v224 offset:160
    s_waitcnt lgkmcnt(0)
    v_cmp_ne_u32_e64 vcc, 0, v9
    s_cmp_eq_u64 vcc, -1
    s_cbranch_scc1 lpolld_40
    s_sleep 4
    s_sub_u32 s69, s69, 1
    s_cmp_lg_u32 s69, 0
    s_cbranch_scc1 lpoll_39
lpolld_40:
    s_lshl_b32 s68, s101, 12
    s_add_u32 s68, s68, 12582912
    s_mov_b32 m0, s79
    s_nop 0
    buffer_load_dwordx4 v18, s[52:55], s68 offen offset:0 sc1 lds
    buffer_load_dwordx4 v18, s[52:55], s68 offen offset:1024 sc1 lds
    buffer_load_dwordx4 v18, s[52:55], s68 offen offset:2048 sc1 lds
    buffer_load_dwordx4 v18, s[52:55], s68 offen offset:3072 sc1 lds
    s_lshl_b32 s68, s65, 19
    s_lshr_b32 s69, s66, 1
    s_lshl_b32 s69, s69, 18
    s_add_u32 s68, s68, s69
    s_and_b32 s69, s66, 1
    s_lshl_b32 s69, s69, 15
    s_add_u32 s68, s68, s69
    s_lshl_b32 s69, s64, 7
    s_add_u32 s68, s68, s69
    s_add_u32 s68, s68, 2048
    s_waitcnt vmcnt(0) lgkmcnt(0)
    ds_read_b64_tr_b16 v[32:33], v20 offset:0
    ds_read_b64_tr_b16 v[34:35], v20 offset:256
    ds_read_b64_tr_b16 v[36:37], v21 offset:0
    ds_read_b64_tr_b16 v[38:39], v21 offset:256
    ds_read_b64_tr_b16 v[40:41], v22 offset:0
    ds_read_b64_tr_b16 v[42:43], v22 offset:256
    ds_read_b64_tr_b16 v[44:45], v23 offset:0
    ds_read_b64_tr_b16 v[46:47], v23 offset:256
    s_waitcnt lgkmcnt(6)
    ds_write_b128 v24, v[32:35] offset:0
    s_waitcnt lgkmcnt(5)
    ds_write_b128 v24, v[36:39] offset:1024
    s_waitcnt lgkmcnt(4)
    ds_write_b128 v24, v[40:43] offset:2048
    s_waitcnt lgkmcnt(3)
    ds_write_b128 v24, v[44:47] offset:3072
    ds_read_b128 v[48:51], v25 offset:0
    ds_read_b128 v[52:55], v25 offset:1024
    ds_read_b128 v[56:59], v25 offset:2048
    ds_read_b128 v[60:63], v25 offset:3072
    s_waitcnt lgkmcnt(3)
    buffer_store_dwordx4 v[48:51], v5, s[56:59], s68 offen nt
    s_add_u32 s68, s68, 65536
    s_waitcnt lgkmcnt(2)
    buffer_store_dwordx4 v[52:55], v5, s[56:59], s68 offen nt
    s_add_u32 s68, s68, 65536
    s_waitcnt lgkmcnt(1)
    buffer_store_dwordx4 v[56:59], v5, s[56:59], s68 offen nt
    s_add_u32 s68, s68, 65536
    s_waitcnt lgkmcnt(0)
    buffer_store_dwordx4 v[60:63], v5, s[56:59], s68 offen nt
    s_add_u32 s68, s68, 65536
L_end:
    s_endpgm

.section .rodata,"a"
.p2align 6
.amdhsa_kernel concat_heads__linear_attn_block__ssm_conv_s4__prompt_kernel
  .amdhsa_next_free_vgpr 256
  .amdhsa_next_free_sgpr 102
  .amdhsa_accum_offset 256
  .amdhsa_group_segment_fixed_size 0
  .amdhsa_kernarg_size 120
  .amdhsa_user_sgpr_count 2
  .amdhsa_user_sgpr_kernarg_segment_ptr 1
  .amdhsa_system_sgpr_workgroup_id_x 1
.end_amdhsa_kernel
```
